```python
import torch

def _softmax(x, axis=-1):
    return torch.softmax(x, dim=axis)
def _gelu(x):
    return torch.nn.functional.gelu(x, approximate="tanh")
def _silu(x):
    return torch.nn.functional.silu(x)
def _sigmoid(x):
    return torch.sigmoid(x)
def _layernorm(x, axis=-1, eps=1e-5):
    m = x.mean(dim=axis, keepdim=True)
    v = x.var(dim=axis, keepdim=True, unbiased=False)
    return (x - m) / torch.sqrt(v + eps)
def _scatter_add(tgt, idx, src, axis=0):
    return tgt.clone().index_add_(axis, idx, src)
def _segment_sum(src, seg, n):
    out = torch.zeros((n,) + src.shape[1:], dtype=src.dtype)
    return out.index_add_(0, seg, src)
def _pad(x, pw):
    flat = tuple(v for pair in reversed(pw) for v in pair)
    return torch.nn.functional.pad(x, flat)

kernel_name = 'standalone__gqa_softmax__near_ridge'

def setup_inputs():

    _w = (lambda a: (lambda t: t.to(torch.bfloat16) if t.is_floating_point() else t)(torch.as_tensor(a)))
    B, Hq, Hkv, Sq, Sk, D = 8, 32, 32, 336, 2048, 128
    return {
        "q": _w((lambda *s: torch.randn(*s, dtype=torch.bfloat16) * 0.8)(B, Hq, Sq, D)),
        "k": _w((lambda *s: torch.randn(*s, dtype=torch.bfloat16) * 0.8)(B, Hkv, Sk, D)),
        "v": _w((lambda *s: torch.randn(*s, dtype=torch.bfloat16) * 0.05)(B, Hkv, Sk, D)),
    }

def reference(q, k, v):
    B, Hq, Sq, D = q.shape
    Hkv = k.shape[1]
    rep = Hq // Hkv
    k = (lambda x, n, axis: torch.repeat_interleave(x, n, dim=axis))(k, rep, axis=1)
    v = (lambda x, n, axis: torch.repeat_interleave(x, n, dim=axis))(v, rep, axis=1)
    scale = D ** -0.5
    scores = torch.einsum("bhqd,bhkd->bhqk", q, k) * scale
    p = _softmax(scores, axis=-1)
    return torch.einsum("bhqk,bhkd->bhqd", p, v)
```

```asm
; @launch grid=(256,1,1) block=(256,1,1) lds=160768
.amdgcn_target "amdgcn-amd-amdhsa--gfx950"
.text
.globl standalone__gqa_softmax__near_ridge_kernel
.p2align 8
.type standalone__gqa_softmax__near_ridge_kernel,@function
standalone__gqa_softmax__near_ridge_kernel:
    s_cmp_ge_u32 s2, 256
    s_cbranch_scc1 L_end
    s_load_dwordx4 s[24:27], s[0:1], 0
    s_load_dwordx4 s[28:31], s[0:1], 16
    v_and_b32 v228, 63, v0
    v_lshrrev_b32 v230, 6, v0
    v_and_b32 v242, 15, v0
    v_readfirstlane_b32 s20, v230
    v_lshrrev_b32 v243, 4, v228
    v_add_u32 v230, 0, v243
    v_add_u32 v231, 4, v243
    v_add_u32 v232, 8, v243
    v_add_u32 v233, 12, v243
    v_xor_b32 v230, v230, v242
    v_xor_b32 v231, v231, v242
    v_xor_b32 v232, v232, v242
    v_xor_b32 v233, v233, v242
    v_lshlrev_b32 v230, 4, v230
    v_lshlrev_b32 v231, 4, v231
    v_lshlrev_b32 v232, 4, v232
    v_lshlrev_b32 v233, 4, v233
    v_lshl_add_u32 v220, v243, 8, v230
    v_lshl_add_u32 v221, v243, 8, v231
    v_lshl_add_u32 v222, v243, 8, v232
    v_lshl_add_u32 v223, v243, 8, v233
    v_lshlrev_b32 v230, 4, v243
    v_lshl_add_u32 v229, v242, 8, v230
    s_lshl_b32 s32, s2, 19
    s_lshr_b32 s33, s2, 13
    s_mul_i32 s34, s2, 86016
    s_mov_b32 s10, 524288
    s_mov_b32 s11, 0x20000
    s_mov_b32 s14, 524288
    s_mov_b32 s15, 0x20000
    s_mov_b32 s6, 86016
    s_mov_b32 s7, 0x20000
    s_mov_b32 s18, 86016
    s_mov_b32 s19, 0x20000
    s_lshl_b32 s22, s20, 12
    s_mov_b32 s21, s22
    s_waitcnt lgkmcnt(0)
    s_add_u32 s8, s26, s32
    s_addc_u32 s9, s27, s33
    s_add_u32 s4, s24, s34
    s_addc_u32 s5, s25, 0
    s_add_u32 m0, s22, 0
    s_nop 0
    buffer_load_dwordx4 v220, s[8:11], s21 offen nt lds
    buffer_load_dwordx4 v221, s[8:11], s21 offen offset:1024 nt lds
    buffer_load_dwordx4 v222, s[8:11], s21 offen offset:2048 nt lds
    buffer_load_dwordx4 v223, s[8:11], s21 offen offset:3072 nt lds
    s_lshl_b32 s35, s20, 2
    v_add_u32 v230, s35, v243
    v_xor_b32 v231, v230, v242
    v_lshlrev_b32 v231, 4, v231
    v_lshl_add_u32 v231, v230, 8, v231
    s_lshl_b32 s35, s20, 10
    s_add_u32 m0, s35, 136192
    s_mov_b32 s35, 81920
    buffer_load_dwordx4 v231, s[4:7], s35 offen nt lds
    s_add_u32 s12, s28, s32
    s_addc_u32 s13, s29, s33
    s_add_u32 s16, s30, s34
    s_addc_u32 s17, s31, 0
    s_mul_i32 s32, s20, 20480
    s_add_u32 s35, s32, 0
    s_nop 0
    buffer_load_dwordx4 v[64:67], v229, s[4:7], s35 offen offset:0 nt
    buffer_load_dwordx4 v[68:71], v229, s[4:7], s35 offen offset:64 nt
    buffer_load_dwordx4 v[72:75], v229, s[4:7], s35 offen offset:128 nt
    buffer_load_dwordx4 v[76:79], v229, s[4:7], s35 offen offset:192 nt
    s_add_u32 s35, s32, 4096
    s_nop 0
    buffer_load_dwordx4 v[80:83], v229, s[4:7], s35 offen offset:0 nt
    v_add_u32 v230, 0, v243
    v_lshlrev_b32 v230, 1, v230
    v_xor_b32 v230, v230, v242
    v_lshlrev_b32 v230, 4, v230
    v_lshl_add_u32 v224, v243, 8, v230
    v_add_u32 v230, 4, v243
    v_lshlrev_b32 v230, 1, v230
    v_xor_b32 v230, v230, v242
    v_lshlrev_b32 v230, 4, v230
    v_lshl_add_u32 v225, v243, 8, v230
    v_add_u32 v230, 0, v243
    v_xor_b32 v230, v230, v242
    v_lshlrev_b32 v230, 4, v230
    v_lshl_add_u32 v204, v242, 8, v230
    v_add_u32 v216, s22, v204
    v_add_u32 v230, 4, v243
    v_xor_b32 v230, v230, v242
    v_lshlrev_b32 v230, 4, v230
    v_lshl_add_u32 v205, v242, 8, v230
    v_add_u32 v217, s22, v205
    v_add_u32 v230, 8, v243
    v_xor_b32 v230, v230, v242
    v_lshlrev_b32 v230, 4, v230
    v_lshl_add_u32 v206, v242, 8, v230
    v_add_u32 v218, s22, v206
    v_add_u32 v230, 12, v243
    v_xor_b32 v230, v230, v242
    v_lshlrev_b32 v230, 4, v230
    v_lshl_add_u32 v207, v242, 8, v230
    v_add_u32 v219, s22, v207
    v_lshrrev_b32 v230, 2, v242
    v_lshl_add_u32 v236, v243, 2, v230
    v_and_b32 v237, 3, v242
    v_lshlrev_b32 v232, 3, v237
    v_lshl_add_u32 v232, v236, 8, v232
    v_add_u32 v232, 65536, v232
    v_and_b32 v231, 7, v236
    s_lshl_b32 s33, s20, 1
    s_xor_b32 s34, s33, 0
    v_xor_b32 v230, s34, v231
    v_lshl_add_u32 v208, v230, 5, v232
    s_xor_b32 s34, s33, 1
    v_xor_b32 v230, s34, v231
    v_lshl_add_u32 v209, v230, 5, v232
    s_xor_b32 s34, s33, 2
    v_xor_b32 v230, s34, v231
    v_lshl_add_u32 v210, v230, 5, v232
    s_xor_b32 s34, s33, 3
    v_xor_b32 v230, s34, v231
    v_lshl_add_u32 v211, v230, 5, v232
    s_xor_b32 s34, s33, 4
    v_xor_b32 v230, s34, v231
    v_lshl_add_u32 v212, v230, 5, v232
    s_xor_b32 s34, s33, 5
    v_xor_b32 v230, s34, v231
    v_lshl_add_u32 v213, v230, 5, v232
    s_xor_b32 s34, s33, 6
    v_xor_b32 v230, s34, v231
    v_lshl_add_u32 v214, v230, 5, v232
    s_xor_b32 s34, s33, 7
    v_xor_b32 v230, s34, v231
    v_lshl_add_u32 v215, v230, 5, v232
    s_lshr_b32 s33, s20, 1
    s_lshl_b32 s33, s33, 10
    s_and_b32 s34, s20, 1
    s_lshl_b32 s34, s34, 3
    s_add_u32 s33, s33, s34
    s_add_u32 s33, s33, 131072
    v_lshlrev_b32 v230, 4, v228
    v_add_u32 v226, s33, v230
    v_add_u32 v227, 131072, v230
    v_cmp_gt_u32 vcc, 8, v242
    v_mov_b32 v230, 0x3f803f80
    v_cndmask_b32 v231, 0, v230, vcc
    v_sub_u32 v232, v230, v231
    v_accvgpr_write_b32 a248, v231
    v_accvgpr_write_b32 a249, v231
    v_accvgpr_write_b32 a250, v231
    v_accvgpr_write_b32 a251, v231
    v_accvgpr_write_b32 a252, v232
    v_accvgpr_write_b32 a253, v232
    v_accvgpr_write_b32 a254, v232
    v_accvgpr_write_b32 a255, v232
    v_and_b32 v230, 1, v242
    v_mul_u32_u24 v230, 10, v230
    v_add_u32 v230, 4, v230
    v_lshl_or_b32 v230, v230, 4, v230
    v_lshl_or_b32 v230, v230, 8, v230
    v_lshl_or_b32 v202, v230, 16, v230
    s_mov_b32 s36, 0x3e0293ee
    s_mov_b32 s37, 0x3e0293ee
    s_mov_b32 s23, 7
    v_and_b32 v248, 15, v228
    v_lshrrev_b32 v249, 4, v228
    s_mul_i32 s33, s20, 5120
    s_add_u32 s33, s33, 140288
    s_mov_b32 s34, 40
    s_mov_b32 s34, 1280
    v_mul_lo_u32 v250, v249, s34
    v_lshl_add_u32 v250, v248, 3, v250
    v_add_u32 v244, s33, v250
    v_lshrrev_b32 v250, 1, v249
    v_mul_lo_u32 v250, v250, s34
    v_and_b32 v251, 1, v249
    v_mul_u32_u24 v251, 640, v251
    v_add_u32 v250, v250, v251
    v_add_u32 v250, s33, v250
    v_lshl_add_u32 v198, v248, 3, v250
    v_bfe_u32 v251, v248, 1, 1
    v_mul_u32_u24 v251, 288, v251
    v_add_u32 v250, v250, v251
    v_and_b32 v251, 1, v248
    v_lshl_add_u32 v250, v251, 6, v250
    v_lshrrev_b32 v251, 2, v248
    v_lshl_add_u32 v245, v251, 3, v250
    s_and_b32 s27, s20, 1
    s_lshl_b32 s27, s27, 1
    v_and_b32 v250, 3, v228
    v_xor_b32 v250, s27, v250
    v_lshlrev_b32 v250, 5, v250
    v_bfe_u32 v251, v228, 2, 1
    v_lshl_add_u32 v250, v251, 4, v250
    v_lshrrev_b32 v247, 3, v228
    v_lshl_add_u32 v247, v247, 8, v250
    v_bfe_u32 v250, v228, 3, 1
    v_lshl_add_u32 v250, v249, 1, v250
    v_lshlrev_b32 v250, 1, v250
    v_bfe_u32 v246, v228, 1, 1
    v_add_u32 v250, v250, v246
    v_lshlrev_b32 v250, 8, v250
    v_lshl_add_u32 v250, v251, 4, v250
    v_and_b32 v251, 1, v228
    v_lshl_add_u32 v246, v251, 5, v250
    v_lshlrev_b32 v250, 2, v228
    s_lshl_b32 s33, s20, 8
    s_add_u32 s33, s33, 131072
    v_add_u32 v242, s33, v250
    v_lshlrev_b32 v250, 4, v249
    v_add_u32 v243, 131072, v250
    s_mov_b32 s24, 0x30800000
    s_mov_b32 s25, 0x71800000
    s_mul_i32 s32, s20, 20480
    s_lshr_b32 s33, s20, 1
    s_lshl_b32 s33, s33, 7
    s_add_u32 s28, s32, s33
    s_xor_b32 s33, s33, 128
    s_add_u32 s29, s32, s33
    s_lshl_b32 s33, s20, 6
    s_add_u32 s26, s33, 81920
    s_waitcnt vmcnt(5)
    s_barrier
    buffer_load_dwordx4 v[84:87], v229, s[4:7], s35 offen offset:64 nt
    buffer_load_dwordx4 v[88:91], v229, s[4:7], s35 offen offset:128 nt
    buffer_load_dwordx4 v[92:95], v229, s[4:7], s35 offen offset:192 nt
    s_add_u32 m0, s22, 65536
    s_nop 0
    buffer_load_dwordx4 v224, s[12:15], s21 offen nt lds
    ds_read_b128 a[0:3], v204 offset:0
    ds_read_b128 a[4:7], v205 offset:0
    ds_read_b128 a[8:11], v206 offset:0
    ds_read_b128 a[12:15], v207 offset:0
    ds_read_b128 a[16:19], v204 offset:4096
    ds_read_b128 a[20:23], v205 offset:4096
    ds_read_b128 a[24:27], v206 offset:4096
    ds_read_b128 a[28:31], v207 offset:4096
    v_add_u32 v248, 136192, v204
    v_add_u32 v249, 136192, v205
    v_add_u32 v250, 136192, v206
    v_add_u32 v251, 136192, v207
    ds_read_b128 v[144:147], v248 offset:0
    ds_read_b128 v[148:151], v249 offset:0
    ds_read_b128 v[152:155], v250 offset:0
    ds_read_b128 v[156:159], v251 offset:0
    ds_read_b128 a[224:227], v216 offset:0
    ds_read_b128 a[228:231], v217 offset:0
    ds_read_b128 a[232:235], v218 offset:0
    ds_read_b128 a[236:239], v219 offset:0
    ds_read_b128 a[32:35], v204 offset:8192
    ds_read_b128 a[36:39], v205 offset:8192
    ds_read_b128 a[40:43], v206 offset:8192
    ds_read_b128 a[44:47], v207 offset:8192
    ds_read_b128 a[48:51], v204 offset:12288
    ds_read_b128 a[52:55], v205 offset:12288
    ds_read_b128 a[56:59], v206 offset:12288
    ds_read_b128 a[60:63], v207 offset:12288
    s_waitcnt vmcnt(5)
    buffer_load_dwordx4 v225, s[12:15], s21 offen offset:1024 nt lds
    buffer_load_dwordx4 v224, s[12:15], s21 offen offset:2048 nt lds
    buffer_load_dwordx4 v225, s[12:15], s21 offen offset:3072 nt lds
    s_add_u32 s35, s32, 8192
    s_nop 0
    buffer_load_dwordx4 v[96:99], v229, s[4:7], s35 offen offset:0 nt
    v_lshlrev_b32 v230, 16, v64
    v_and_b32 v231, 0xffff0000, v64
    v_lshlrev_b32 v232, 16, v65
    v_and_b32 v233, 0xffff0000, v65
    v_lshlrev_b32 v234, 16, v66
    v_and_b32 v235, 0xffff0000, v66
    v_lshlrev_b32 v236, 16, v67
    v_and_b32 v237, 0xffff0000, v67
    v_pk_mul_f32 v[230:231], v[230:231], s[36:37]
    v_pk_mul_f32 v[232:233], v[232:233], s[36:37]
    v_pk_mul_f32 v[234:235], v[234:235], s[36:37]
    v_pk_mul_f32 v[236:237], v[236:237], s[36:37]
    v_cvt_pk_bf16_f32 v238, v230, v231
    v_cvt_pk_bf16_f32 v239, v232, v233
    v_cvt_pk_bf16_f32 v240, v234, v235
    v_cvt_pk_bf16_f32 v241, v236, v237
    v_accvgpr_write_b32 a128, v238
    v_accvgpr_write_b32 a129, v239
    v_accvgpr_write_b32 a130, v240
    v_accvgpr_write_b32 a131, v241
    v_lshlrev_b32 v230, 16, v68
    v_and_b32 v231, 0xffff0000, v68
    v_lshlrev_b32 v232, 16, v69
    v_and_b32 v233, 0xffff0000, v69
    v_lshlrev_b32 v234, 16, v70
    v_and_b32 v235, 0xffff0000, v70
    v_lshlrev_b32 v236, 16, v71
    v_and_b32 v237, 0xffff0000, v71
    v_pk_mul_f32 v[230:231], v[230:231], s[36:37]
    v_pk_mul_f32 v[232:233], v[232:233], s[36:37]
    v_pk_mul_f32 v[234:235], v[234:235], s[36:37]
    v_pk_mul_f32 v[236:237], v[236:237], s[36:37]
    v_cvt_pk_bf16_f32 v238, v230, v231
    v_cvt_pk_bf16_f32 v239, v232, v233
    v_cvt_pk_bf16_f32 v240, v234, v235
    v_cvt_pk_bf16_f32 v241, v236, v237
    v_accvgpr_write_b32 a132, v238
    v_accvgpr_write_b32 a133, v239
    v_accvgpr_write_b32 a134, v240
    v_accvgpr_write_b32 a135, v241
    v_lshlrev_b32 v230, 16, v72
    v_and_b32 v231, 0xffff0000, v72
    v_lshlrev_b32 v232, 16, v73
    v_and_b32 v233, 0xffff0000, v73
    v_lshlrev_b32 v234, 16, v74
    v_and_b32 v235, 0xffff0000, v74
    v_lshlrev_b32 v236, 16, v75
    v_and_b32 v237, 0xffff0000, v75
    v_pk_mul_f32 v[230:231], v[230:231], s[36:37]
    v_pk_mul_f32 v[232:233], v[232:233], s[36:37]
    v_pk_mul_f32 v[234:235], v[234:235], s[36:37]
    v_pk_mul_f32 v[236:237], v[236:237], s[36:37]
    v_cvt_pk_bf16_f32 v238, v230, v231
    v_cvt_pk_bf16_f32 v239, v232, v233
    v_cvt_pk_bf16_f32 v240, v234, v235
    v_cvt_pk_bf16_f32 v241, v236, v237
    v_accvgpr_write_b32 a136, v238
    v_accvgpr_write_b32 a137, v239
    v_accvgpr_write_b32 a138, v240
    v_accvgpr_write_b32 a139, v241
    v_lshlrev_b32 v230, 16, v76
    v_and_b32 v231, 0xffff0000, v76
    v_lshlrev_b32 v232, 16, v77
    v_and_b32 v233, 0xffff0000, v77
    v_lshlrev_b32 v234, 16, v78
    v_and_b32 v235, 0xffff0000, v78
    v_lshlrev_b32 v236, 16, v79
    v_and_b32 v237, 0xffff0000, v79
    v_pk_mul_f32 v[230:231], v[230:231], s[36:37]
    v_pk_mul_f32 v[232:233], v[232:233], s[36:37]
    v_pk_mul_f32 v[234:235], v[234:235], s[36:37]
    v_pk_mul_f32 v[236:237], v[236:237], s[36:37]
    v_cvt_pk_bf16_f32 v238, v230, v231
    v_cvt_pk_bf16_f32 v239, v232, v233
    v_cvt_pk_bf16_f32 v240, v234, v235
    v_cvt_pk_bf16_f32 v241, v236, v237
    v_accvgpr_write_b32 a140, v238
    v_accvgpr_write_b32 a141, v239
    v_accvgpr_write_b32 a142, v240
    v_accvgpr_write_b32 a143, v241
    buffer_load_dwordx4 v[100:103], v229, s[4:7], s35 offen offset:64 nt
    s_waitcnt lgkmcnt(0)
    v_mfma_f32_16x16x32_bf16 v[168:171], a[0:3], a[128:131], 0
    v_mfma_f32_16x16x32_bf16 v[168:171], a[4:7], a[132:135], v[168:171]
    v_mfma_f32_16x16x32_bf16 v[168:171], a[8:11], a[136:139], v[168:171]
    v_mfma_f32_16x16x32_bf16 v[168:171], a[12:15], a[140:143], v[168:171]
    v_mfma_f32_16x16x32_bf16 v[172:175], a[16:19], a[128:131], 0
    v_mfma_f32_16x16x32_bf16 v[172:175], a[20:23], a[132:135], v[172:175]
    v_mfma_f32_16x16x32_bf16 v[172:175], a[24:27], a[136:139], v[172:175]
    v_mfma_f32_16x16x32_bf16 v[172:175], a[28:31], a[140:143], v[172:175]
    v_mfma_f32_16x16x32_bf16 v[176:179], a[32:35], a[128:131], 0
    s_nop 2
    v_exp_f32 v168, v168
    v_mfma_f32_16x16x32_bf16 v[176:179], a[36:39], a[132:135], v[176:179]
    v_exp_f32 v169, v169
    v_mfma_f32_16x16x32_bf16 v[176:179], a[40:43], a[136:139], v[176:179]
    v_exp_f32 v170, v170
    v_cvt_pk_bf16_f32 v184, v168, v169
    v_mfma_f32_16x16x32_bf16 v[176:179], a[44:47], a[140:143], v[176:179]
    v_exp_f32 v171, v171
    v_mfma_f32_16x16x32_bf16 v[180:183], a[48:51], a[128:131], 0
    v_exp_f32 v172, v172
    v_cvt_pk_bf16_f32 v185, v170, v171
    v_mfma_f32_16x16x32_bf16 v[180:183], a[52:55], a[132:135], v[180:183]
    v_exp_f32 v173, v173
    v_mfma_f32_16x16x32_bf16 v[180:183], a[56:59], a[136:139], v[180:183]
    v_exp_f32 v174, v174
    v_cvt_pk_bf16_f32 v186, v172, v173
    v_mfma_f32_16x16x32_bf16 v[180:183], a[60:63], a[140:143], v[180:183]
    v_exp_f32 v175, v175
    s_nop 0
    v_cvt_pk_bf16_f32 v187, v174, v175
    buffer_load_dwordx4 v[104:107], v229, s[4:7], s35 offen offset:128 nt
    v_lshlrev_b32 v230, 16, v144
    v_and_b32 v231, 0xffff0000, v144
    v_lshlrev_b32 v232, 16, v145
    v_and_b32 v233, 0xffff0000, v145
    v_lshlrev_b32 v234, 16, v146
    v_and_b32 v235, 0xffff0000, v146
    v_lshlrev_b32 v236, 16, v147
    v_and_b32 v237, 0xffff0000, v147
    v_pk_mul_f32 v[230:231], v[230:231], s[36:37]
    v_pk_mul_f32 v[232:233], v[232:233], s[36:37]
    v_pk_mul_f32 v[234:235], v[234:235], s[36:37]
    v_pk_mul_f32 v[236:237], v[236:237], s[36:37]
    v_cvt_pk_bf16_f32 v238, v230, v231
    v_cvt_pk_bf16_f32 v239, v232, v233
    v_cvt_pk_bf16_f32 v240, v234, v235
    v_cvt_pk_bf16_f32 v241, v236, v237
    v_accvgpr_write_b32 a208, v238
    v_accvgpr_write_b32 a209, v239
    v_accvgpr_write_b32 a210, v240
    v_accvgpr_write_b32 a211, v241
    v_lshlrev_b32 v230, 16, v148
    v_and_b32 v231, 0xffff0000, v148
    v_lshlrev_b32 v232, 16, v149
    v_and_b32 v233, 0xffff0000, v149
    v_lshlrev_b32 v234, 16, v150
    v_and_b32 v235, 0xffff0000, v150
    v_lshlrev_b32 v236, 16, v151
    v_and_b32 v237, 0xffff0000, v151
    v_pk_mul_f32 v[230:231], v[230:231], s[36:37]
    v_pk_mul_f32 v[232:233], v[232:233], s[36:37]
    v_pk_mul_f32 v[234:235], v[234:235], s[36:37]
    v_pk_mul_f32 v[236:237], v[236:237], s[36:37]
    v_cvt_pk_bf16_f32 v238, v230, v231
    v_cvt_pk_bf16_f32 v239, v232, v233
    v_cvt_pk_bf16_f32 v240, v234, v235
    v_cvt_pk_bf16_f32 v241, v236, v237
    v_accvgpr_write_b32 a212, v238
    v_accvgpr_write_b32 a213, v239
    v_accvgpr_write_b32 a214, v240
    v_accvgpr_write_b32 a215, v241
    v_lshlrev_b32 v230, 16, v152
    v_and_b32 v231, 0xffff0000, v152
    v_lshlrev_b32 v232, 16, v153
    v_and_b32 v233, 0xffff0000, v153
    v_lshlrev_b32 v234, 16, v154
    v_and_b32 v235, 0xffff0000, v154
    v_lshlrev_b32 v236, 16, v155
    v_and_b32 v237, 0xffff0000, v155
    v_pk_mul_f32 v[230:231], v[230:231], s[36:37]
    v_pk_mul_f32 v[232:233], v[232:233], s[36:37]
    v_pk_mul_f32 v[234:235], v[234:235], s[36:37]
    v_pk_mul_f32 v[236:237], v[236:237], s[36:37]
    v_cvt_pk_bf16_f32 v238, v230, v231
    v_cvt_pk_bf16_f32 v239, v232, v233
    v_cvt_pk_bf16_f32 v240, v234, v235
    v_cvt_pk_bf16_f32 v241, v236, v237
    v_accvgpr_write_b32 a216, v238
    v_accvgpr_write_b32 a217, v239
    v_accvgpr_write_b32 a218, v240
    v_accvgpr_write_b32 a219, v241
    v_lshlrev_b32 v230, 16, v156
    v_and_b32 v231, 0xffff0000, v156
    v_lshlrev_b32 v232, 16, v157
    v_and_b32 v233, 0xffff0000, v157
    v_lshlrev_b32 v234, 16, v158
    v_and_b32 v235, 0xffff0000, v158
    v_lshlrev_b32 v236, 16, v159
    v_and_b32 v237, 0xffff0000, v159
    v_pk_mul_f32 v[230:231], v[230:231], s[36:37]
    v_pk_mul_f32 v[232:233], v[232:233], s[36:37]
    v_pk_mul_f32 v[234:235], v[234:235], s[36:37]
    v_pk_mul_f32 v[236:237], v[236:237], s[36:37]
    v_cvt_pk_bf16_f32 v238, v230, v231
    v_cvt_pk_bf16_f32 v239, v232, v233
    v_cvt_pk_bf16_f32 v240, v234, v235
    v_cvt_pk_bf16_f32 v241, v236, v237
    v_accvgpr_write_b32 a220, v238
    v_accvgpr_write_b32 a221, v239
    v_accvgpr_write_b32 a222, v240
    v_accvgpr_write_b32 a223, v241
    buffer_load_dwordx4 v[108:111], v229, s[4:7], s35 offen offset:192 nt
    v_mfma_f32_16x16x32_bf16 v[192:195], a[224:227], a[208:211], 0
    v_exp_f32 v176, v176
    v_exp_f32 v177, v177
    v_mfma_f32_16x16x32_bf16 v[192:195], a[228:231], a[212:215], v[192:195]
    v_exp_f32 v178, v178
    v_cvt_pk_bf16_f32 v188, v176, v177
    v_exp_f32 v179, v179
    v_mfma_f32_16x16x32_bf16 v[192:195], a[232:235], a[216:219], v[192:195]
    v_exp_f32 v180, v180
    v_cvt_pk_bf16_f32 v189, v178, v179
    v_exp_f32 v181, v181
    v_mfma_f32_16x16x32_bf16 v[192:195], a[236:239], a[220:223], v[192:195]
    v_exp_f32 v182, v182
    v_cvt_pk_bf16_f32 v190, v180, v181
    v_exp_f32 v183, v183
    s_nop 0
    v_cvt_pk_bf16_f32 v191, v182, v183
    s_waitcnt vmcnt(8)
    s_add_u32 s35, s32, 12288
    s_nop 0
    buffer_load_dwordx4 v[112:115], v229, s[4:7], s35 offen offset:0 nt
    v_lshlrev_b32 v230, 16, v80
    v_and_b32 v231, 0xffff0000, v80
    v_lshlrev_b32 v232, 16, v81
    v_and_b32 v233, 0xffff0000, v81
    v_lshlrev_b32 v234, 16, v82
    v_and_b32 v235, 0xffff0000, v82
    v_lshlrev_b32 v236, 16, v83
    v_and_b32 v237, 0xffff0000, v83
    v_pk_mul_f32 v[230:231], v[230:231], s[36:37]
    v_pk_mul_f32 v[232:233], v[232:233], s[36:37]
    v_pk_mul_f32 v[234:235], v[234:235], s[36:37]
    v_pk_mul_f32 v[236:237], v[236:237], s[36:37]
    v_cvt_pk_bf16_f32 v238, v230, v231
    v_cvt_pk_bf16_f32 v239, v232, v233
    v_cvt_pk_bf16_f32 v240, v234, v235
    v_cvt_pk_bf16_f32 v241, v236, v237
    v_accvgpr_write_b32 a144, v238
    v_accvgpr_write_b32 a145, v239
    v_accvgpr_write_b32 a146, v240
    v_accvgpr_write_b32 a147, v241
    v_lshlrev_b32 v230, 16, v84
    v_and_b32 v231, 0xffff0000, v84
    v_lshlrev_b32 v232, 16, v85
    v_and_b32 v233, 0xffff0000, v85
    v_lshlrev_b32 v234, 16, v86
    v_and_b32 v235, 0xffff0000, v86
    v_lshlrev_b32 v236, 16, v87
    v_and_b32 v237, 0xffff0000, v87
    v_pk_mul_f32 v[230:231], v[230:231], s[36:37]
    v_pk_mul_f32 v[232:233], v[232:233], s[36:37]
    v_pk_mul_f32 v[234:235], v[234:235], s[36:37]
    v_pk_mul_f32 v[236:237], v[236:237], s[36:37]
    v_cvt_pk_bf16_f32 v238, v230, v231
    v_cvt_pk_bf16_f32 v239, v232, v233
    v_cvt_pk_bf16_f32 v240, v234, v235
    v_cvt_pk_bf16_f32 v241, v236, v237
    v_accvgpr_write_b32 a148, v238
    v_accvgpr_write_b32 a149, v239
    v_accvgpr_write_b32 a150, v240
    v_accvgpr_write_b32 a151, v241
    v_lshlrev_b32 v230, 16, v88
    v_and_b32 v231, 0xffff0000, v88
    v_lshlrev_b32 v232, 16, v89
    v_and_b32 v233, 0xffff0000, v89
    v_lshlrev_b32 v234, 16, v90
    v_and_b32 v235, 0xffff0000, v90
    v_lshlrev_b32 v236, 16, v91
    v_and_b32 v237, 0xffff0000, v91
    v_pk_mul_f32 v[230:231], v[230:231], s[36:37]
    v_pk_mul_f32 v[232:233], v[232:233], s[36:37]
    v_pk_mul_f32 v[234:235], v[234:235], s[36:37]
    v_pk_mul_f32 v[236:237], v[236:237], s[36:37]
    v_cvt_pk_bf16_f32 v238, v230, v231
    v_cvt_pk_bf16_f32 v239, v232, v233
    v_cvt_pk_bf16_f32 v240, v234, v235
    v_cvt_pk_bf16_f32 v241, v236, v237
    v_accvgpr_write_b32 a152, v238
    v_accvgpr_write_b32 a153, v239
    v_accvgpr_write_b32 a154, v240
    v_accvgpr_write_b32 a155, v241
    v_lshlrev_b32 v230, 16, v92
    v_and_b32 v231, 0xffff0000, v92
    v_lshlrev_b32 v232, 16, v93
    v_and_b32 v233, 0xffff0000, v93
    v_lshlrev_b32 v234, 16, v94
    v_and_b32 v235, 0xffff0000, v94
    v_lshlrev_b32 v236, 16, v95
    v_and_b32 v237, 0xffff0000, v95
    v_pk_mul_f32 v[230:231], v[230:231], s[36:37]
    v_pk_mul_f32 v[232:233], v[232:233], s[36:37]
    v_pk_mul_f32 v[234:235], v[234:235], s[36:37]
    v_pk_mul_f32 v[236:237], v[236:237], s[36:37]
    v_cvt_pk_bf16_f32 v238, v230, v231
    v_cvt_pk_bf16_f32 v239, v232, v233
    v_cvt_pk_bf16_f32 v240, v234, v235
    v_cvt_pk_bf16_f32 v241, v236, v237
    v_accvgpr_write_b32 a156, v238
    v_accvgpr_write_b32 a157, v239
    v_accvgpr_write_b32 a158, v240
    v_accvgpr_write_b32 a159, v241
    buffer_load_dwordx4 v[116:119], v229, s[4:7], s35 offen offset:64 nt
    buffer_load_dwordx4 v[120:123], v229, s[4:7], s35 offen offset:128 nt
    v_mfma_f32_16x16x32_bf16 v[168:171], a[0:3], a[144:147], 0
    v_mfma_f32_16x16x32_bf16 v[168:171], a[4:7], a[148:151], v[168:171]
    v_mfma_f32_16x16x32_bf16 v[168:171], a[8:11], a[152:155], v[168:171]
    v_mfma_f32_16x16x32_bf16 v[168:171], a[12:15], a[156:159], v[168:171]
    v_mfma_f32_16x16x32_bf16 v[172:175], a[16:19], a[144:147], 0
    v_mfma_f32_16x16x32_bf16 v[172:175], a[20:23], a[148:151], v[172:175]
    v_mfma_f32_16x16x32_bf16 v[172:175], a[24:27], a[152:155], v[172:175]
    v_mfma_f32_16x16x32_bf16 v[172:175], a[28:31], a[156:159], v[172:175]
    v_mfma_f32_16x16x32_bf16 v[176:179], a[32:35], a[144:147], 0
    v_exp_f32 v192, v192
    v_mfma_f32_16x16x32_bf16 v[176:179], a[36:39], a[148:151], v[176:179]
    v_exp_f32 v193, v193
    v_mfma_f32_16x16x32_bf16 v[176:179], a[40:43], a[152:155], v[176:179]
    v_exp_f32 v194, v194
    v_mfma_f32_16x16x32_bf16 v[176:179], a[44:47], a[156:159], v[176:179]
    v_exp_f32 v195, v195
    v_mfma_f32_16x16x32_bf16 v[180:183], a[48:51], a[144:147], 0
    v_cvt_pk_bf16_f32 v196, v192, v193
    v_cvt_pk_bf16_f32 v197, v194, v195
    v_mfma_f32_16x16x32_bf16 v[180:183], a[52:55], a[148:151], v[180:183]
    v_mfma_f32_16x16x32_bf16 v[180:183], a[56:59], a[152:155], v[180:183]
    v_mfma_f32_16x16x32_bf16 v[180:183], a[60:63], a[156:159], v[180:183]
    ds_write_b64 v226, v[196:197] offset:0
    v_mov_b32 v234, 0
    v_mov_b32 v235, 0
    v_mov_b32 v236, 0
    v_mov_b32 v237, 0
    v_mov_b32 v238, 0
    v_mov_b32 v239, 0
    v_mov_b32 v240, 0
    v_mov_b32 v241, 0
    v_mov_b32 v230, 0
    v_mov_b32 v231, 0
    v_mov_b32 v232, 0
    v_mov_b32 v233, 0
    s_waitcnt vmcnt(7) lgkmcnt(0)
    s_barrier
    buffer_load_dwordx4 v[124:127], v229, s[4:7], s35 offen offset:192 nt
    s_add_u32 s35, s32, 16384
    s_nop 0
    buffer_load_dwordx4 v[128:131], v229, s[4:7], s35 offen offset:0 nt
    ds_read_b64_tr_b16 a[72:73], v210 offset:0
    ds_read_b64_tr_b16 a[74:75], v210 offset:4096
    ds_read_b64_tr_b16 a[104:105], v210 offset:8192
    ds_read_b64_tr_b16 a[106:107], v210 offset:12288
    ds_read_b64_tr_b16 a[108:109], v211 offset:8192
    ds_read_b64_tr_b16 a[110:111], v211 offset:12288
    ds_read_b64_tr_b16 a[76:77], v211 offset:0
    ds_read_b64_tr_b16 a[78:79], v211 offset:4096
    ds_read_b64_tr_b16 a[80:81], v212 offset:0
    ds_read_b64_tr_b16 a[82:83], v212 offset:4096
    ds_read_b64_tr_b16 a[112:113], v212 offset:8192
    ds_read_b64_tr_b16 a[114:115], v212 offset:12288
    ds_read_b64_tr_b16 a[116:117], v213 offset:8192
    ds_read_b64_tr_b16 a[118:119], v213 offset:12288
    ds_read_b64_tr_b16 a[84:85], v213 offset:0
    ds_read_b64_tr_b16 a[86:87], v213 offset:4096
    ds_read_b64_tr_b16 a[88:89], v214 offset:0
    ds_read_b64_tr_b16 a[90:91], v214 offset:4096
    ds_read_b64_tr_b16 a[120:121], v214 offset:8192
    ds_read_b64_tr_b16 a[122:123], v214 offset:12288
    ds_read_b64_tr_b16 a[124:125], v215 offset:8192
    ds_read_b64_tr_b16 a[126:127], v215 offset:12288
    ds_read_b64_tr_b16 a[92:93], v215 offset:0
    ds_read_b64_tr_b16 a[94:95], v215 offset:4096
    ds_read_b64_tr_b16 a[64:65], v208 offset:0
    ds_read_b64_tr_b16 a[66:67], v208 offset:4096
    ds_read_b64_tr_b16 a[96:97], v208 offset:8192
    ds_read_b64_tr_b16 a[98:99], v208 offset:12288
    ds_read_b64_tr_b16 a[100:101], v209 offset:8192
    ds_read_b64_tr_b16 a[102:103], v209 offset:12288
    ds_read_b64_tr_b16 a[68:69], v209 offset:0
    ds_read_b64_tr_b16 a[70:71], v209 offset:4096
    v_exp_f32 v168, v168
    v_exp_f32 v169, v169
    v_exp_f32 v170, v170
    v_cvt_pk_bf16_f32 v248, v168, v169
    v_exp_f32 v171, v171
    v_exp_f32 v172, v172
    v_smfmac_f32_16x16x64_bf16 v[234:237], a[248:251], v[184:191], v202
    s_waitcnt lgkmcnt(7)
    v_cvt_pk_bf16_f32 v249, v170, v171
    v_mfma_f32_16x16x32_bf16 v[8:11], v[184:187], a[72:75], 0
    v_exp_f32 v173, v173
    v_mfma_f32_16x16x32_bf16 v[8:11], v[188:191], a[104:107], v[8:11]
    v_exp_f32 v174, v174
    v_cvt_pk_bf16_f32 v250, v172, v173
    v_mfma_f32_16x16x32_bf16 v[12:15], v[188:191], a[108:111], 0
    v_exp_f32 v175, v175
    v_mfma_f32_16x16x32_bf16 v[12:15], v[184:187], a[76:79], v[12:15]
    v_cvt_pk_bf16_f32 v251, v174, v175
    v_mfma_f32_16x16x32_bf16 v[16:19], v[184:187], a[80:83], 0
    v_exp_f32 v176, v176
    v_mfma_f32_16x16x32_bf16 v[16:19], v[188:191], a[112:115], v[16:19]
    v_exp_f32 v177, v177
    v_mfma_f32_16x16x32_bf16 v[20:23], v[188:191], a[116:119], 0
    v_exp_f32 v178, v178
    v_cvt_pk_bf16_f32 v252, v176, v177
    v_mfma_f32_16x16x32_bf16 v[20:23], v[184:187], a[84:87], v[20:23]
    v_exp_f32 v179, v179
    v_mfma_f32_16x16x32_bf16 v[24:27], v[184:187], a[88:91], 0
    v_exp_f32 v180, v180
    v_mfma_f32_16x16x32_bf16 v[24:27], v[188:191], a[120:123], v[24:27]
    v_cvt_pk_bf16_f32 v253, v178, v179
    v_mfma_f32_16x16x32_bf16 v[28:31], v[188:191], a[124:127], 0
    v_exp_f32 v181, v181
    v_mfma_f32_16x16x32_bf16 v[28:31], v[184:187], a[92:95], v[28:31]
    s_waitcnt lgkmcnt(0)
    v_exp_f32 v182, v182
    v_cvt_pk_bf16_f32 v254, v180, v181
    v_mfma_f32_16x16x32_bf16 v[0:3], v[184:187], a[64:67], 0
    v_exp_f32 v183, v183
    v_mfma_f32_16x16x32_bf16 v[0:3], v[188:191], a[96:99], v[0:3]
    v_cvt_pk_bf16_f32 v255, v182, v183
    v_mfma_f32_16x16x32_bf16 v[4:7], v[188:191], a[100:103], 0
    v_mfma_f32_16x16x32_bf16 v[4:7], v[184:187], a[68:71], v[4:7]
    buffer_load_dwordx4 v[132:135], v229, s[4:7], s35 offen offset:64 nt
    buffer_load_dwordx4 v[136:139], v229, s[4:7], s35 offen offset:128 nt
    s_waitcnt vmcnt(7)
    buffer_load_dwordx4 v[140:143], v229, s[4:7], s35 offen offset:192 nt
    s_add_u32 s38, s22, 16384
    s_add_u32 m0, s22, 16384
    s_nop 0
    buffer_load_dwordx4 v220, s[8:11], s38 offen nt lds
    v_smfmac_f32_16x16x64_bf16 v[234:237], a[252:255], v[248:255], v202
    v_lshlrev_b32 v64, 16, v96
    v_and_b32 v65, 0xffff0000, v96
    v_lshlrev_b32 v66, 16, v97
    v_and_b32 v67, 0xffff0000, v97
    v_lshlrev_b32 v68, 16, v98
    v_and_b32 v69, 0xffff0000, v98
    v_lshlrev_b32 v70, 16, v99
    v_and_b32 v71, 0xffff0000, v99
    v_mfma_f32_16x16x32_bf16 v[40:43], v[248:251], a[72:75], 0
    v_pk_mul_f32 v[64:65], v[64:65], s[36:37]
    v_pk_mul_f32 v[66:67], v[66:67], s[36:37]
    v_pk_mul_f32 v[68:69], v[68:69], s[36:37]
    v_pk_mul_f32 v[70:71], v[70:71], s[36:37]
    v_cvt_pk_bf16_f32 v72, v64, v65
    v_cvt_pk_bf16_f32 v73, v66, v67
    v_cvt_pk_bf16_f32 v74, v68, v69
    v_cvt_pk_bf16_f32 v75, v70, v71
    v_accvgpr_write_b32 a160, v72
    v_mfma_f32_16x16x32_bf16 v[40:43], v[252:255], a[104:107], v[40:43]
    v_accvgpr_write_b32 a161, v73
    v_accvgpr_write_b32 a162, v74
    v_accvgpr_write_b32 a163, v75
    v_lshlrev_b32 v64, 16, v100
    v_and_b32 v65, 0xffff0000, v100
    v_lshlrev_b32 v66, 16, v101
    v_and_b32 v67, 0xffff0000, v101
    v_lshlrev_b32 v68, 16, v102
    v_and_b32 v69, 0xffff0000, v102
    v_mfma_f32_16x16x32_bf16 v[44:47], v[252:255], a[108:111], 0
    v_lshlrev_b32 v70, 16, v103
    v_and_b32 v71, 0xffff0000, v103
    v_pk_mul_f32 v[64:65], v[64:65], s[36:37]
    v_pk_mul_f32 v[66:67], v[66:67], s[36:37]
    v_pk_mul_f32 v[68:69], v[68:69], s[36:37]
    v_pk_mul_f32 v[70:71], v[70:71], s[36:37]
    v_cvt_pk_bf16_f32 v72, v64, v65
    v_cvt_pk_bf16_f32 v73, v66, v67
    v_cvt_pk_bf16_f32 v74, v68, v69
    v_mfma_f32_16x16x32_bf16 v[44:47], v[248:251], a[76:79], v[44:47]
    v_cvt_pk_bf16_f32 v75, v70, v71
    v_accvgpr_write_b32 a164, v72
    v_accvgpr_write_b32 a165, v73
    v_accvgpr_write_b32 a166, v74
    v_accvgpr_write_b32 a167, v75
    v_lshlrev_b32 v64, 16, v104
    v_and_b32 v65, 0xffff0000, v104
    v_lshlrev_b32 v66, 16, v105
    v_and_b32 v67, 0xffff0000, v105
    v_mfma_f32_16x16x32_bf16 v[48:51], v[248:251], a[80:83], 0
    v_lshlrev_b32 v68, 16, v106
    v_and_b32 v69, 0xffff0000, v106
    v_lshlrev_b32 v70, 16, v107
    v_and_b32 v71, 0xffff0000, v107
    v_pk_mul_f32 v[64:65], v[64:65], s[36:37]
    v_pk_mul_f32 v[66:67], v[66:67], s[36:37]
    v_pk_mul_f32 v[68:69], v[68:69], s[36:37]
    v_pk_mul_f32 v[70:71], v[70:71], s[36:37]
    v_cvt_pk_bf16_f32 v72, v64, v65
    v_mfma_f32_16x16x32_bf16 v[48:51], v[252:255], a[112:115], v[48:51]
    v_cvt_pk_bf16_f32 v73, v66, v67
    v_cvt_pk_bf16_f32 v74, v68, v69
    v_cvt_pk_bf16_f32 v75, v70, v71
    v_accvgpr_write_b32 a168, v72
    v_accvgpr_write_b32 a169, v73
    v_accvgpr_write_b32 a170, v74
    v_accvgpr_write_b32 a171, v75
    v_lshlrev_b32 v64, 16, v108
    v_and_b32 v65, 0xffff0000, v108
    v_mfma_f32_16x16x32_bf16 v[52:55], v[252:255], a[116:119], 0
    v_lshlrev_b32 v66, 16, v109
    v_and_b32 v67, 0xffff0000, v109
    v_lshlrev_b32 v68, 16, v110
    v_and_b32 v69, 0xffff0000, v110
    v_lshlrev_b32 v70, 16, v111
    v_and_b32 v71, 0xffff0000, v111
    v_pk_mul_f32 v[64:65], v[64:65], s[36:37]
    v_pk_mul_f32 v[66:67], v[66:67], s[36:37]
    v_pk_mul_f32 v[68:69], v[68:69], s[36:37]
    v_mfma_f32_16x16x32_bf16 v[52:55], v[248:251], a[84:87], v[52:55]
    v_pk_mul_f32 v[70:71], v[70:71], s[36:37]
    v_cvt_pk_bf16_f32 v72, v64, v65
    v_cvt_pk_bf16_f32 v73, v66, v67
    v_cvt_pk_bf16_f32 v74, v68, v69
    v_cvt_pk_bf16_f32 v75, v70, v71
    v_accvgpr_write_b32 a172, v72
    v_accvgpr_write_b32 a173, v73
    v_accvgpr_write_b32 a174, v74
    v_accvgpr_write_b32 a175, v75
    buffer_load_dwordx4 v221, s[8:11], s38 offen offset:1024 nt lds
    v_mfma_f32_16x16x32_bf16 v[168:171], a[0:3], a[160:163], 0
    v_mfma_f32_16x16x32_bf16 v[168:171], a[4:7], a[164:167], v[168:171]
    v_mfma_f32_16x16x32_bf16 v[168:171], a[8:11], a[168:171], v[168:171]
    v_mfma_f32_16x16x32_bf16 v[168:171], a[12:15], a[172:175], v[168:171]
    v_mfma_f32_16x16x32_bf16 v[172:175], a[16:19], a[160:163], 0
    v_mfma_f32_16x16x32_bf16 v[172:175], a[20:23], a[164:167], v[172:175]
    v_mfma_f32_16x16x32_bf16 v[172:175], a[24:27], a[168:171], v[172:175]
    v_mfma_f32_16x16x32_bf16 v[172:175], a[28:31], a[172:175], v[172:175]
    v_mfma_f32_16x16x32_bf16 v[176:179], a[32:35], a[160:163], 0
    s_nop 2
    v_exp_f32 v168, v168
    v_mfma_f32_16x16x32_bf16 v[176:179], a[36:39], a[164:167], v[176:179]
    v_exp_f32 v169, v169
    v_mfma_f32_16x16x32_bf16 v[176:179], a[40:43], a[168:171], v[176:179]
    v_exp_f32 v170, v170
    v_cvt_pk_bf16_f32 v184, v168, v169
    v_mfma_f32_16x16x32_bf16 v[176:179], a[44:47], a[172:175], v[176:179]
    v_exp_f32 v171, v171
    v_mfma_f32_16x16x32_bf16 v[180:183], a[48:51], a[160:163], 0
    v_exp_f32 v172, v172
    v_cvt_pk_bf16_f32 v185, v170, v171
    v_mfma_f32_16x16x32_bf16 v[180:183], a[52:55], a[164:167], v[180:183]
    v_exp_f32 v173, v173
    v_mfma_f32_16x16x32_bf16 v[180:183], a[56:59], a[168:171], v[180:183]
    v_exp_f32 v174, v174
    v_cvt_pk_bf16_f32 v186, v172, v173
    v_mfma_f32_16x16x32_bf16 v[180:183], a[60:63], a[172:175], v[180:183]
    v_exp_f32 v175, v175
    s_nop 0
    v_cvt_pk_bf16_f32 v187, v174, v175
    buffer_load_dwordx4 v222, s[8:11], s38 offen offset:2048 nt lds
    v_mfma_f32_16x16x32_bf16 v[56:59], v[248:251], a[88:91], 0
    v_exp_f32 v176, v176
    v_mfma_f32_16x16x32_bf16 v[56:59], v[252:255], a[120:123], v[56:59]
    v_exp_f32 v177, v177
    v_mfma_f32_16x16x32_bf16 v[60:63], v[252:255], a[124:127], 0
    v_exp_f32 v178, v178
    v_cvt_pk_bf16_f32 v188, v176, v177
    v_mfma_f32_16x16x32_bf16 v[60:63], v[248:251], a[92:95], v[60:63]
    v_exp_f32 v179, v179
    v_mfma_f32_16x16x32_bf16 v[32:35], v[248:251], a[64:67], 0
    v_exp_f32 v180, v180
    v_cvt_pk_bf16_f32 v189, v178, v179
    v_mfma_f32_16x16x32_bf16 v[32:35], v[252:255], a[96:99], v[32:35]
    v_exp_f32 v181, v181
    v_mfma_f32_16x16x32_bf16 v[36:39], v[252:255], a[100:103], 0
    v_exp_f32 v182, v182
    v_cvt_pk_bf16_f32 v190, v180, v181
    v_mfma_f32_16x16x32_bf16 v[36:39], v[248:251], a[68:71], v[36:39]
    v_exp_f32 v183, v183
    s_nop 0
    v_cvt_pk_bf16_f32 v191, v182, v183
    s_waitcnt vmcnt(7)
    buffer_load_dwordx4 v223, s[8:11], s38 offen offset:3072 nt lds
    s_add_u32 m0, s22, 81920
    s_nop 0
    buffer_load_dwordx4 v224, s[12:15], s38 offen nt lds
    v_smfmac_f32_16x16x64_bf16 v[238:241], a[248:251], v[184:191], v202
    v_lshlrev_b32 v96, 16, v112
    v_and_b32 v97, 0xffff0000, v112
    v_lshlrev_b32 v98, 16, v113
    v_and_b32 v99, 0xffff0000, v113
    v_lshlrev_b32 v100, 16, v114
    v_and_b32 v101, 0xffff0000, v114
    v_lshlrev_b32 v102, 16, v115
    v_and_b32 v103, 0xffff0000, v115
    v_mfma_f32_16x16x32_bf16 v[72:75], v[184:187], a[72:75], 0
    v_pk_mul_f32 v[96:97], v[96:97], s[36:37]
    v_pk_mul_f32 v[98:99], v[98:99], s[36:37]
    v_pk_mul_f32 v[100:101], v[100:101], s[36:37]
    v_pk_mul_f32 v[102:103], v[102:103], s[36:37]
    v_cvt_pk_bf16_f32 v104, v96, v97
    v_cvt_pk_bf16_f32 v105, v98, v99
    v_cvt_pk_bf16_f32 v106, v100, v101
    v_cvt_pk_bf16_f32 v107, v102, v103
    v_accvgpr_write_b32 a176, v104
    v_mfma_f32_16x16x32_bf16 v[72:75], v[188:191], a[104:107], v[72:75]
    v_accvgpr_write_b32 a177, v105
    v_accvgpr_write_b32 a178, v106
    v_accvgpr_write_b32 a179, v107
    v_lshlrev_b32 v96, 16, v116
    v_and_b32 v97, 0xffff0000, v116
    v_lshlrev_b32 v98, 16, v117
    v_and_b32 v99, 0xffff0000, v117
    v_lshlrev_b32 v100, 16, v118
    v_and_b32 v101, 0xffff0000, v118
    v_mfma_f32_16x16x32_bf16 v[76:79], v[188:191], a[108:111], 0
    v_lshlrev_b32 v102, 16, v119
    v_and_b32 v103, 0xffff0000, v119
    v_pk_mul_f32 v[96:97], v[96:97], s[36:37]
    v_pk_mul_f32 v[98:99], v[98:99], s[36:37]
    v_pk_mul_f32 v[100:101], v[100:101], s[36:37]
    v_pk_mul_f32 v[102:103], v[102:103], s[36:37]
    v_cvt_pk_bf16_f32 v104, v96, v97
    v_cvt_pk_bf16_f32 v105, v98, v99
    v_cvt_pk_bf16_f32 v106, v100, v101
    v_mfma_f32_16x16x32_bf16 v[76:79], v[184:187], a[76:79], v[76:79]
    v_cvt_pk_bf16_f32 v107, v102, v103
    v_accvgpr_write_b32 a180, v104
    v_accvgpr_write_b32 a181, v105
    v_accvgpr_write_b32 a182, v106
    v_accvgpr_write_b32 a183, v107
    v_lshlrev_b32 v96, 16, v120
    v_and_b32 v97, 0xffff0000, v120
    v_lshlrev_b32 v98, 16, v121
    v_and_b32 v99, 0xffff0000, v121
    v_mfma_f32_16x16x32_bf16 v[80:83], v[184:187], a[80:83], 0
    v_lshlrev_b32 v100, 16, v122
    v_and_b32 v101, 0xffff0000, v122
    v_lshlrev_b32 v102, 16, v123
    v_and_b32 v103, 0xffff0000, v123
    v_pk_mul_f32 v[96:97], v[96:97], s[36:37]
    v_pk_mul_f32 v[98:99], v[98:99], s[36:37]
    v_pk_mul_f32 v[100:101], v[100:101], s[36:37]
    v_pk_mul_f32 v[102:103], v[102:103], s[36:37]
    v_cvt_pk_bf16_f32 v104, v96, v97
    v_mfma_f32_16x16x32_bf16 v[80:83], v[188:191], a[112:115], v[80:83]
    v_cvt_pk_bf16_f32 v105, v98, v99
    v_cvt_pk_bf16_f32 v106, v100, v101
    v_cvt_pk_bf16_f32 v107, v102, v103
    v_accvgpr_write_b32 a184, v104
    v_accvgpr_write_b32 a185, v105
    v_accvgpr_write_b32 a186, v106
    v_accvgpr_write_b32 a187, v107
    v_lshlrev_b32 v96, 16, v124
    v_and_b32 v97, 0xffff0000, v124
    v_mfma_f32_16x16x32_bf16 v[84:87], v[188:191], a[116:119], 0
    v_lshlrev_b32 v98, 16, v125
    v_and_b32 v99, 0xffff0000, v125
    v_lshlrev_b32 v100, 16, v126
    v_and_b32 v101, 0xffff0000, v126
    v_lshlrev_b32 v102, 16, v127
    v_and_b32 v103, 0xffff0000, v127
    v_pk_mul_f32 v[96:97], v[96:97], s[36:37]
    v_pk_mul_f32 v[98:99], v[98:99], s[36:37]
    v_pk_mul_f32 v[100:101], v[100:101], s[36:37]
    v_mfma_f32_16x16x32_bf16 v[84:87], v[184:187], a[84:87], v[84:87]
    v_pk_mul_f32 v[102:103], v[102:103], s[36:37]
    v_cvt_pk_bf16_f32 v104, v96, v97
    v_cvt_pk_bf16_f32 v105, v98, v99
    v_cvt_pk_bf16_f32 v106, v100, v101
    v_cvt_pk_bf16_f32 v107, v102, v103
    v_accvgpr_write_b32 a188, v104
    v_accvgpr_write_b32 a189, v105
    v_accvgpr_write_b32 a190, v106
    v_accvgpr_write_b32 a191, v107
    buffer_load_dwordx4 v225, s[12:15], s38 offen offset:1024 nt lds
    v_mfma_f32_16x16x32_bf16 v[168:171], a[0:3], a[176:179], 0
    v_mfma_f32_16x16x32_bf16 v[168:171], a[4:7], a[180:183], v[168:171]
    v_mfma_f32_16x16x32_bf16 v[168:171], a[8:11], a[184:187], v[168:171]
    v_mfma_f32_16x16x32_bf16 v[168:171], a[12:15], a[188:191], v[168:171]
    v_mfma_f32_16x16x32_bf16 v[172:175], a[16:19], a[176:179], 0
    v_mfma_f32_16x16x32_bf16 v[172:175], a[20:23], a[180:183], v[172:175]
    v_mfma_f32_16x16x32_bf16 v[172:175], a[24:27], a[184:187], v[172:175]
    v_mfma_f32_16x16x32_bf16 v[172:175], a[28:31], a[188:191], v[172:175]
    v_mfma_f32_16x16x32_bf16 v[176:179], a[32:35], a[176:179], 0
    s_nop 2
    v_exp_f32 v168, v168
    v_mfma_f32_16x16x32_bf16 v[176:179], a[36:39], a[180:183], v[176:179]
    v_exp_f32 v169, v169
    v_mfma_f32_16x16x32_bf16 v[176:179], a[40:43], a[184:187], v[176:179]
    v_exp_f32 v170, v170
    v_mfma_f32_16x16x32_bf16 v[176:179], a[44:47], a[188:191], v[176:179]
    v_cvt_pk_bf16_f32 v248, v168, v169
    v_mfma_f32_16x16x32_bf16 v[180:183], a[48:51], a[176:179], 0
    v_exp_f32 v171, v171
    v_mfma_f32_16x16x32_bf16 v[180:183], a[52:55], a[180:183], v[180:183]
    v_exp_f32 v172, v172
    v_cvt_pk_bf16_f32 v249, v170, v171
    v_mfma_f32_16x16x32_bf16 v[180:183], a[56:59], a[184:187], v[180:183]
    v_exp_f32 v173, v173
    v_mfma_f32_16x16x32_bf16 v[180:183], a[60:63], a[188:191], v[180:183]
    v_cvt_pk_bf16_f32 v250, v172, v173
    buffer_load_dwordx4 v224, s[12:15], s38 offen offset:2048 nt lds
    v_mfma_f32_16x16x32_bf16 v[88:91], v[184:187], a[88:91], 0
    v_exp_f32 v174, v174
    v_mfma_f32_16x16x32_bf16 v[88:91], v[188:191], a[120:123], v[88:91]
    v_exp_f32 v175, v175
    v_mfma_f32_16x16x32_bf16 v[92:95], v[188:191], a[124:127], 0
    v_exp_f32 v176, v176
    v_mfma_f32_16x16x32_bf16 v[92:95], v[184:187], a[92:95], v[92:95]
    v_cvt_pk_bf16_f32 v251, v174, v175
    v_mfma_f32_16x16x32_bf16 v[64:67], v[184:187], a[64:67], 0
    v_exp_f32 v177, v177
    v_mfma_f32_16x16x32_bf16 v[64:67], v[188:191], a[96:99], v[64:67]
    v_exp_f32 v178, v178
    v_cvt_pk_bf16_f32 v252, v176, v177
    v_mfma_f32_16x16x32_bf16 v[68:71], v[188:191], a[100:103], 0
    v_exp_f32 v179, v179
    v_mfma_f32_16x16x32_bf16 v[68:71], v[184:187], a[68:71], v[68:71]
    v_cvt_pk_bf16_f32 v253, v178, v179
    s_waitcnt vmcnt(10)
    v_lshlrev_b32 v144, 16, v128
    v_and_b32 v145, 0xffff0000, v128
    v_lshlrev_b32 v146, 16, v129
    v_and_b32 v147, 0xffff0000, v129
    v_lshlrev_b32 v148, 16, v130
    v_and_b32 v149, 0xffff0000, v130
    v_lshlrev_b32 v150, 16, v131
    v_and_b32 v151, 0xffff0000, v131
    v_pk_mul_f32 v[144:145], v[144:145], s[36:37]
    v_pk_mul_f32 v[146:147], v[146:147], s[36:37]
    v_pk_mul_f32 v[148:149], v[148:149], s[36:37]
    v_pk_mul_f32 v[150:151], v[150:151], s[36:37]
    v_cvt_pk_bf16_f32 v152, v144, v145
    v_cvt_pk_bf16_f32 v153, v146, v147
    v_cvt_pk_bf16_f32 v154, v148, v149
    v_cvt_pk_bf16_f32 v155, v150, v151
    v_accvgpr_write_b32 a192, v152
    v_accvgpr_write_b32 a193, v153
    v_accvgpr_write_b32 a194, v154
    v_accvgpr_write_b32 a195, v155
    s_waitcnt vmcnt(9)
    v_lshlrev_b32 v144, 16, v132
    v_and_b32 v145, 0xffff0000, v132
    v_lshlrev_b32 v146, 16, v133
    v_and_b32 v147, 0xffff0000, v133
    v_lshlrev_b32 v148, 16, v134
    v_and_b32 v149, 0xffff0000, v134
    v_lshlrev_b32 v150, 16, v135
    v_and_b32 v151, 0xffff0000, v135
    v_pk_mul_f32 v[144:145], v[144:145], s[36:37]
    v_pk_mul_f32 v[146:147], v[146:147], s[36:37]
    v_pk_mul_f32 v[148:149], v[148:149], s[36:37]
    v_pk_mul_f32 v[150:151], v[150:151], s[36:37]
    v_cvt_pk_bf16_f32 v152, v144, v145
    v_cvt_pk_bf16_f32 v153, v146, v147
    v_cvt_pk_bf16_f32 v154, v148, v149
    v_cvt_pk_bf16_f32 v155, v150, v151
    v_accvgpr_write_b32 a196, v152
    v_accvgpr_write_b32 a197, v153
    v_accvgpr_write_b32 a198, v154
    v_accvgpr_write_b32 a199, v155
    s_waitcnt vmcnt(8)
    buffer_load_dwordx4 v225, s[12:15], s38 offen offset:3072 nt lds
    v_lshlrev_b32 v144, 16, v136
    v_and_b32 v145, 0xffff0000, v136
    v_lshlrev_b32 v146, 16, v137
    v_and_b32 v147, 0xffff0000, v137
    v_lshlrev_b32 v148, 16, v138
    v_and_b32 v149, 0xffff0000, v138
    v_lshlrev_b32 v150, 16, v139
    v_and_b32 v151, 0xffff0000, v139
    v_pk_mul_f32 v[144:145], v[144:145], s[36:37]
    v_pk_mul_f32 v[146:147], v[146:147], s[36:37]
    v_pk_mul_f32 v[148:149], v[148:149], s[36:37]
    v_pk_mul_f32 v[150:151], v[150:151], s[36:37]
    v_cvt_pk_bf16_f32 v152, v144, v145
    v_cvt_pk_bf16_f32 v153, v146, v147
    v_cvt_pk_bf16_f32 v154, v148, v149
    v_cvt_pk_bf16_f32 v155, v150, v151
    v_accvgpr_write_b32 a200, v152
    v_accvgpr_write_b32 a201, v153
    v_accvgpr_write_b32 a202, v154
    v_accvgpr_write_b32 a203, v155
    s_waitcnt vmcnt(8)
    s_add_u32 s39, s22, 32768
    s_add_u32 m0, s22, 32768
    s_nop 0
    buffer_load_dwordx4 v220, s[8:11], s39 offen nt lds
    v_lshlrev_b32 v144, 16, v140
    v_and_b32 v145, 0xffff0000, v140
    v_lshlrev_b32 v146, 16, v141
    v_and_b32 v147, 0xffff0000, v141
    v_lshlrev_b32 v148, 16, v142
    v_and_b32 v149, 0xffff0000, v142
    v_lshlrev_b32 v150, 16, v143
    v_and_b32 v151, 0xffff0000, v143
    v_pk_mul_f32 v[144:145], v[144:145], s[36:37]
    v_pk_mul_f32 v[146:147], v[146:147], s[36:37]
    v_pk_mul_f32 v[148:149], v[148:149], s[36:37]
    v_pk_mul_f32 v[150:151], v[150:151], s[36:37]
    v_cvt_pk_bf16_f32 v152, v144, v145
    v_cvt_pk_bf16_f32 v153, v146, v147
    v_cvt_pk_bf16_f32 v154, v148, v149
    v_cvt_pk_bf16_f32 v155, v150, v151
    v_accvgpr_write_b32 a204, v152
    v_accvgpr_write_b32 a205, v153
    v_accvgpr_write_b32 a206, v154
    v_accvgpr_write_b32 a207, v155
    v_mfma_f32_16x16x32_bf16 v[168:171], a[0:3], a[192:195], 0
    v_exp_f32 v180, v180
    v_mfma_f32_16x16x32_bf16 v[168:171], a[4:7], a[196:199], v[168:171]
    buffer_load_dwordx4 v221, s[8:11], s39 offen offset:1024 nt lds
    v_mfma_f32_16x16x32_bf16 v[168:171], a[8:11], a[200:203], v[168:171]
    v_exp_f32 v181, v181
    v_mfma_f32_16x16x32_bf16 v[168:171], a[12:15], a[204:207], v[168:171]
    v_cvt_pk_bf16_f32 v254, v180, v181
    v_mfma_f32_16x16x32_bf16 v[172:175], a[16:19], a[192:195], 0
    v_exp_f32 v182, v182
    v_mfma_f32_16x16x32_bf16 v[172:175], a[20:23], a[196:199], v[172:175]
    v_mfma_f32_16x16x32_bf16 v[172:175], a[24:27], a[200:203], v[172:175]
    v_exp_f32 v183, v183
    v_mfma_f32_16x16x32_bf16 v[172:175], a[28:31], a[204:207], v[172:175]
    v_cvt_pk_bf16_f32 v255, v182, v183
    v_mfma_f32_16x16x32_bf16 v[176:179], a[32:35], a[192:195], 0
    v_exp_f32 v168, v168
    v_mfma_f32_16x16x32_bf16 v[176:179], a[36:39], a[196:199], v[176:179]
    v_mfma_f32_16x16x32_bf16 v[176:179], a[40:43], a[200:203], v[176:179]
    v_exp_f32 v169, v169
    v_mfma_f32_16x16x32_bf16 v[176:179], a[44:47], a[204:207], v[176:179]
    v_cvt_pk_bf16_f32 v184, v168, v169
    v_mfma_f32_16x16x32_bf16 v[180:183], a[48:51], a[192:195], 0
    v_exp_f32 v170, v170
    v_mfma_f32_16x16x32_bf16 v[180:183], a[52:55], a[196:199], v[180:183]
    buffer_load_dwordx4 v222, s[8:11], s39 offen offset:2048 nt lds
    v_mfma_f32_16x16x32_bf16 v[180:183], a[56:59], a[200:203], v[180:183]
    v_exp_f32 v171, v171
    v_mfma_f32_16x16x32_bf16 v[180:183], a[60:63], a[204:207], v[180:183]
    v_cvt_pk_bf16_f32 v185, v170, v171
    v_smfmac_f32_16x16x64_bf16 v[238:241], a[252:255], v[248:255], v202
    s_waitcnt vmcnt(7) lgkmcnt(0)
    s_barrier
    v_mfma_f32_16x16x32_bf16 v[104:107], v[248:251], a[72:75], 0
    v_exp_f32 v172, v172
    v_mfma_f32_16x16x32_bf16 v[104:107], v[252:255], a[104:107], v[104:107]
    ds_read_b128 a[224:227], v216 offset:16384
    v_mfma_f32_16x16x32_bf16 v[108:111], v[252:255], a[108:111], 0
    v_exp_f32 v173, v173
    v_mfma_f32_16x16x32_bf16 v[108:111], v[248:251], a[76:79], v[108:111]
    ds_read_b128 a[228:231], v217 offset:16384
    v_cvt_pk_bf16_f32 v186, v172, v173
    v_mfma_f32_16x16x32_bf16 v[112:115], v[248:251], a[80:83], 0
    v_exp_f32 v174, v174
    v_mfma_f32_16x16x32_bf16 v[112:115], v[252:255], a[112:115], v[112:115]
    ds_read_b128 a[232:235], v218 offset:16384
    v_mfma_f32_16x16x32_bf16 v[116:119], v[252:255], a[116:119], 0
    v_exp_f32 v175, v175
    v_mfma_f32_16x16x32_bf16 v[116:119], v[248:251], a[84:87], v[116:119]
    ds_read_b128 a[236:239], v219 offset:16384
    v_cvt_pk_bf16_f32 v187, v174, v175
    v_mfma_f32_16x16x32_bf16 v[120:123], v[248:251], a[88:91], 0
    ds_read_b128 a[0:3], v204 offset:16384
    v_exp_f32 v176, v176
    v_mfma_f32_16x16x32_bf16 v[120:123], v[252:255], a[120:123], v[120:123]
    ds_read_b128 a[4:7], v205 offset:16384
    v_mfma_f32_16x16x32_bf16 v[124:127], v[252:255], a[124:127], 0
    ds_read_b128 a[8:11], v206 offset:16384
    v_exp_f32 v177, v177
    v_mfma_f32_16x16x32_bf16 v[124:127], v[248:251], a[92:95], v[124:127]
    ds_read_b128 a[12:15], v207 offset:16384
    v_cvt_pk_bf16_f32 v188, v176, v177
    v_mfma_f32_16x16x32_bf16 v[96:99], v[248:251], a[64:67], 0
    ds_read_b128 a[16:19], v204 offset:20480
    v_exp_f32 v178, v178
    v_mfma_f32_16x16x32_bf16 v[96:99], v[252:255], a[96:99], v[96:99]
    ds_read_b128 a[20:23], v205 offset:20480
    v_mfma_f32_16x16x32_bf16 v[100:103], v[252:255], a[100:103], 0
    ds_read_b128 a[24:27], v206 offset:20480
    v_exp_f32 v179, v179
    v_mfma_f32_16x16x32_bf16 v[100:103], v[248:251], a[68:71], v[100:103]
    s_waitcnt lgkmcnt(5)
    ds_read_b128 a[28:31], v207 offset:20480
    v_cvt_pk_bf16_f32 v189, v178, v179
    v_mfma_f32_16x16x32_bf16 v[192:195], a[224:227], a[208:211], 0
    ds_read_b128 a[32:35], v204 offset:24576
    v_mfma_f32_16x16x32_bf16 v[192:195], a[228:231], a[212:215], v[192:195]
    ds_read_b128 a[36:39], v205 offset:24576
    v_mfma_f32_16x16x32_bf16 v[192:195], a[232:235], a[216:219], v[192:195]
    ds_read_b128 a[40:43], v206 offset:24576
    v_mfma_f32_16x16x32_bf16 v[192:195], a[236:239], a[220:223], v[192:195]
    ds_read_b128 a[44:47], v207 offset:24576
    v_mfma_f32_16x16x32_bf16 v[168:171], a[0:3], a[128:131], 0
    ds_read_b128 a[48:51], v204 offset:28672
    v_exp_f32 v180, v180
    v_mfma_f32_16x16x32_bf16 v[168:171], a[4:7], a[132:135], v[168:171]
    s_waitcnt lgkmcnt(6)
    ds_read_b128 a[52:55], v205 offset:28672
    v_mfma_f32_16x16x32_bf16 v[168:171], a[8:11], a[136:139], v[168:171]
    ds_read_b128 a[56:59], v206 offset:28672
    v_exp_f32 v181, v181
    v_mfma_f32_16x16x32_bf16 v[168:171], a[12:15], a[140:143], v[168:171]
    ds_read_b128 a[60:63], v207 offset:28672
    v_cvt_pk_bf16_f32 v190, v180, v181
    v_mfma_f32_16x16x32_bf16 v[172:175], a[16:19], a[128:131], 0
    v_exp_f32 v182, v182
    v_mfma_f32_16x16x32_bf16 v[172:175], a[20:23], a[132:135], v[172:175]
    buffer_load_dwordx4 v223, s[8:11], s39 offen offset:3072 nt lds
    v_mfma_f32_16x16x32_bf16 v[172:175], a[24:27], a[136:139], v[172:175]
    s_waitcnt lgkmcnt(3)
    v_exp_f32 v183, v183
    v_mfma_f32_16x16x32_bf16 v[172:175], a[28:31], a[140:143], v[172:175]
    ds_read_b128 a[240:243], v227 offset:0
    v_cvt_pk_bf16_f32 v191, v182, v183
    v_mfma_f32_16x16x32_bf16 v[176:179], a[32:35], a[128:131], 0
    v_exp_f32 v168, v168
    s_add_u32 m0, s22, 98304
    v_mfma_f32_16x16x32_bf16 v[176:179], a[36:39], a[132:135], v[176:179]
    buffer_load_dwordx4 v224, s[12:15], s39 offen nt lds
    v_mfma_f32_16x16x32_bf16 v[176:179], a[40:43], a[136:139], v[176:179]
    v_exp_f32 v169, v169
    v_mfma_f32_16x16x32_bf16 v[176:179], a[44:47], a[140:143], v[176:179]
    ds_read_b128 a[244:247], v227 offset:1024
    v_cvt_pk_bf16_f32 v248, v168, v169
    v_mfma_f32_16x16x32_bf16 v[180:183], a[48:51], a[128:131], 0
    s_waitcnt lgkmcnt(2)
    v_exp_f32 v170, v170
    v_mfma_f32_16x16x32_bf16 v[180:183], a[52:55], a[132:135], v[180:183]
    buffer_load_dwordx4 v225, s[12:15], s39 offen offset:1024 nt lds
    v_mfma_f32_16x16x32_bf16 v[180:183], a[56:59], a[136:139], v[180:183]
    v_exp_f32 v171, v171
    v_mfma_f32_16x16x32_bf16 v[180:183], a[60:63], a[140:143], v[180:183]
    v_cvt_pk_bf16_f32 v249, v170, v171
    v_smfmac_f32_16x16x64_bf16 v[230:233], a[248:251], v[184:191], v202
    v_mfma_f32_16x16x32_bf16 v[136:139], v[184:187], a[72:75], 0
    v_exp_f32 v172, v172
    v_mfma_f32_16x16x32_bf16 v[136:139], v[188:191], a[104:107], v[136:139]
    v_mfma_f32_16x16x32_bf16 v[140:143], v[188:191], a[108:111], 0
    v_exp_f32 v173, v173
    v_mfma_f32_16x16x32_bf16 v[140:143], v[184:187], a[76:79], v[140:143]
    v_cvt_pk_bf16_f32 v250, v172, v173
    v_mfma_f32_16x16x32_bf16 v[144:147], v[184:187], a[80:83], 0
    v_exp_f32 v174, v174
    v_mfma_f32_16x16x32_bf16 v[144:147], v[188:191], a[112:115], v[144:147]
    v_mfma_f32_16x16x32_bf16 v[148:151], v[188:191], a[116:119], 0
    v_exp_f32 v175, v175
    v_mfma_f32_16x16x32_bf16 v[148:151], v[184:187], a[84:87], v[148:151]
    v_cvt_pk_bf16_f32 v251, v174, v175
    v_mfma_f32_16x16x32_bf16 v[152:155], v[184:187], a[88:91], 0
    v_exp_f32 v176, v176
    v_mfma_f32_16x16x32_bf16 v[152:155], v[188:191], a[120:123], v[152:155]
    buffer_load_dwordx4 v224, s[12:15], s39 offen offset:2048 nt lds
    v_mfma_f32_16x16x32_bf16 v[156:159], v[188:191], a[124:127], 0
    v_exp_f32 v177, v177
    v_mfma_f32_16x16x32_bf16 v[156:159], v[184:187], a[92:95], v[156:159]
    v_cvt_pk_bf16_f32 v252, v176, v177
    v_mfma_f32_16x16x32_bf16 v[128:131], v[184:187], a[64:67], 0
    v_exp_f32 v178, v178
    v_mfma_f32_16x16x32_bf16 v[128:131], v[188:191], a[96:99], v[128:131]
    v_mfma_f32_16x16x32_bf16 v[132:135], v[188:191], a[100:103], 0
    v_exp_f32 v179, v179
    v_mfma_f32_16x16x32_bf16 v[132:135], v[184:187], a[68:71], v[132:135]
    s_waitcnt lgkmcnt(0)
    v_cvt_pk_bf16_f32 v253, v178, v179
    v_smfmac_f32_16x16x64_bf16 v[230:233], a[252:255], a[240:247], v202
    v_mfma_f32_16x16x32_bf16 v[160:163], a[240:243], a[64:67], 0
    v_mfma_f32_16x16x32_bf16 v[160:163], a[244:247], a[96:99], v[160:163]
    s_waitcnt vmcnt(7)
    s_barrier
    v_mfma_f32_16x16x32_bf16 v[164:167], a[244:247], a[100:103], 0
    ds_read_b64_tr_b16 a[72:73], v210 offset:16384
    ds_read_b64_tr_b16 a[74:75], v210 offset:20480
    v_mfma_f32_16x16x32_bf16 v[164:167], a[240:243], a[68:71], v[164:167]
    ds_read_b64_tr_b16 a[104:105], v210 offset:24576
    ds_read_b64_tr_b16 a[106:107], v210 offset:28672
    v_mfma_f32_16x16x32_bf16 v[168:171], a[0:3], a[144:147], 0
    v_exp_f32 v180, v180
    v_mfma_f32_16x16x32_bf16 v[168:171], a[4:7], a[148:151], v[168:171]
    ds_read_b64_tr_b16 a[108:109], v211 offset:24576
    ds_read_b64_tr_b16 a[110:111], v211 offset:28672
    v_mfma_f32_16x16x32_bf16 v[168:171], a[8:11], a[152:155], v[168:171]
    v_exp_f32 v181, v181
    v_mfma_f32_16x16x32_bf16 v[168:171], a[12:15], a[156:159], v[168:171]
    ds_read_b64_tr_b16 a[76:77], v211 offset:16384
    v_cvt_pk_bf16_f32 v254, v180, v181
    v_mfma_f32_16x16x32_bf16 v[172:175], a[16:19], a[144:147], 0
    v_exp_f32 v182, v182
    v_mfma_f32_16x16x32_bf16 v[172:175], a[20:23], a[148:151], v[172:175]
    ds_read_b64_tr_b16 a[78:79], v211 offset:20480
    ds_read_b64_tr_b16 a[80:81], v212 offset:16384
    v_mfma_f32_16x16x32_bf16 v[172:175], a[24:27], a[152:155], v[172:175]
    v_exp_f32 v183, v183
    v_mfma_f32_16x16x32_bf16 v[172:175], a[28:31], a[156:159], v[172:175]
    ds_read_b64_tr_b16 a[82:83], v212 offset:20480
    v_cvt_pk_bf16_f32 v255, v182, v183
    v_mfma_f32_16x16x32_bf16 v[176:179], a[32:35], a[144:147], 0
    v_exp_f32 v168, v168
    v_mfma_f32_16x16x32_bf16 v[176:179], a[36:39], a[148:151], v[176:179]
    ds_read_b64_tr_b16 a[112:113], v212 offset:24576
    ds_read_b64_tr_b16 a[114:115], v212 offset:28672
    v_mfma_f32_16x16x32_bf16 v[176:179], a[40:43], a[152:155], v[176:179]
    v_exp_f32 v169, v169
    v_mfma_f32_16x16x32_bf16 v[176:179], a[44:47], a[156:159], v[176:179]
    ds_read_b64_tr_b16 a[116:117], v213 offset:24576
    ds_read_b64_tr_b16 a[118:119], v213 offset:28672
    v_cvt_pk_bf16_f32 v184, v168, v169
    v_mfma_f32_16x16x32_bf16 v[180:183], a[48:51], a[144:147], 0
    ds_read_b64_tr_b16 a[84:85], v213 offset:16384
    ds_read_b64_tr_b16 a[86:87], v213 offset:20480
    v_exp_f32 v170, v170
    v_mfma_f32_16x16x32_bf16 v[180:183], a[52:55], a[148:151], v[180:183]
    ds_read_b64_tr_b16 a[88:89], v214 offset:16384
    ds_read_b64_tr_b16 a[90:91], v214 offset:20480
    v_mfma_f32_16x16x32_bf16 v[180:183], a[56:59], a[152:155], v[180:183]
    ds_read_b64_tr_b16 a[120:121], v214 offset:24576
    ds_read_b64_tr_b16 a[122:123], v214 offset:28672
    v_exp_f32 v171, v171
    v_mfma_f32_16x16x32_bf16 v[180:183], a[60:63], a[156:159], v[180:183]
    ds_read_b64_tr_b16 a[124:125], v215 offset:24576
    ds_read_b64_tr_b16 a[126:127], v215 offset:28672
    v_cvt_pk_bf16_f32 v185, v170, v171
    v_smfmac_f32_16x16x64_bf16 v[234:237], a[248:251], v[248:255], v202
    s_waitcnt lgkmcnt(7)
    ds_read_b64_tr_b16 a[92:93], v215 offset:16384
    ds_read_b64_tr_b16 a[94:95], v215 offset:20480
    v_mfma_f32_16x16x32_bf16 v[8:11], v[248:251], a[72:75], v[8:11]
    ds_read_b64_tr_b16 a[64:65], v208 offset:16384
    ds_read_b64_tr_b16 a[66:67], v208 offset:20480
    v_exp_f32 v172, v172
    v_mfma_f32_16x16x32_bf16 v[8:11], v[252:255], a[104:107], v[8:11]
    ds_read_b64_tr_b16 a[96:97], v208 offset:24576
    ds_read_b64_tr_b16 a[98:99], v208 offset:28672
    buffer_load_dwordx4 v225, s[12:15], s39 offen offset:3072 nt lds
    v_mfma_f32_16x16x32_bf16 v[12:15], v[252:255], a[108:111], v[12:15]
    ds_read_b64_tr_b16 a[100:101], v209 offset:24576
    ds_read_b64_tr_b16 a[102:103], v209 offset:28672
    v_exp_f32 v173, v173
    v_mfma_f32_16x16x32_bf16 v[12:15], v[248:251], a[76:79], v[12:15]
    ds_read_b64_tr_b16 a[68:69], v209 offset:16384
    ds_read_b64_tr_b16 a[70:71], v209 offset:20480
    v_cvt_pk_bf16_f32 v186, v172, v173
    v_mfma_f32_16x16x32_bf16 v[16:19], v[248:251], a[80:83], v[16:19]
    v_exp_f32 v174, v174
    s_add_u32 s38, s22, 49152
    s_add_u32 m0, s22, 49152
    v_mfma_f32_16x16x32_bf16 v[16:19], v[252:255], a[112:115], v[16:19]
    buffer_load_dwordx4 v220, s[8:11], s38 offen nt lds
    v_mfma_f32_16x16x32_bf16 v[20:23], v[252:255], a[116:119], v[20:23]
    s_waitcnt lgkmcnt(4)
    v_exp_f32 v175, v175
    v_mfma_f32_16x16x32_bf16 v[20:23], v[248:251], a[84:87], v[20:23]
    v_cvt_pk_bf16_f32 v187, v174, v175
    v_mfma_f32_16x16x32_bf16 v[24:27], v[248:251], a[88:91], v[24:27]
    v_exp_f32 v176, v176
    v_mfma_f32_16x16x32_bf16 v[24:27], v[252:255], a[120:123], v[24:27]
    buffer_load_dwordx4 v221, s[8:11], s38 offen offset:1024 nt lds
    v_mfma_f32_16x16x32_bf16 v[28:31], v[252:255], a[124:127], v[28:31]
    v_exp_f32 v177, v177
    v_mfma_f32_16x16x32_bf16 v[28:31], v[248:251], a[92:95], v[28:31]
    v_cvt_pk_bf16_f32 v188, v176, v177
    v_mfma_f32_16x16x32_bf16 v[0:3], v[248:251], a[64:67], v[0:3]
    v_exp_f32 v178, v178
    v_mfma_f32_16x16x32_bf16 v[0:3], v[252:255], a[96:99], v[0:3]
    s_waitcnt lgkmcnt(0)
    v_exp_f32 v192, v192
    v_mfma_f32_16x16x32_bf16 v[4:7], v[252:255], a[100:103], v[4:7]
    v_exp_f32 v179, v179
    v_mfma_f32_16x16x32_bf16 v[4:7], v[248:251], a[68:71], v[4:7]
    v_cvt_pk_bf16_f32 v189, v178, v179
    v_mfma_f32_16x16x32_bf16 v[168:171], a[0:3], a[160:163], 0
    v_exp_f32 v180, v180
    v_mfma_f32_16x16x32_bf16 v[168:171], a[4:7], a[164:167], v[168:171]
    v_exp_f32 v193, v193
    v_mfma_f32_16x16x32_bf16 v[168:171], a[8:11], a[168:171], v[168:171]
    v_exp_f32 v181, v181
    v_mfma_f32_16x16x32_bf16 v[168:171], a[12:15], a[172:175], v[168:171]
    v_cvt_pk_bf16_f32 v190, v180, v181
    v_cvt_pk_bf16_f32 v196, v192, v193
    v_mfma_f32_16x16x32_bf16 v[172:175], a[16:19], a[160:163], 0
    v_exp_f32 v182, v182
    v_mfma_f32_16x16x32_bf16 v[172:175], a[20:23], a[164:167], v[172:175]
    buffer_load_dwordx4 v222, s[8:11], s38 offen offset:2048 nt lds
    v_mfma_f32_16x16x32_bf16 v[172:175], a[24:27], a[168:171], v[172:175]
    v_exp_f32 v183, v183
    v_mfma_f32_16x16x32_bf16 v[172:175], a[28:31], a[172:175], v[172:175]
    v_cvt_pk_bf16_f32 v191, v182, v183
    v_mfma_f32_16x16x32_bf16 v[176:179], a[32:35], a[160:163], 0
    v_exp_f32 v168, v168
    v_mfma_f32_16x16x32_bf16 v[176:179], a[36:39], a[164:167], v[176:179]
    v_exp_f32 v194, v194
    v_mfma_f32_16x16x32_bf16 v[176:179], a[40:43], a[168:171], v[176:179]
    v_exp_f32 v169, v169
    v_mfma_f32_16x16x32_bf16 v[176:179], a[44:47], a[172:175], v[176:179]
    v_cvt_pk_bf16_f32 v248, v168, v169
    v_mfma_f32_16x16x32_bf16 v[180:183], a[48:51], a[160:163], 0
    v_exp_f32 v170, v170
    v_mfma_f32_16x16x32_bf16 v[180:183], a[52:55], a[164:167], v[180:183]
    v_exp_f32 v195, v195
    v_mfma_f32_16x16x32_bf16 v[180:183], a[56:59], a[168:171], v[180:183]
    v_exp_f32 v171, v171
    v_mfma_f32_16x16x32_bf16 v[180:183], a[60:63], a[172:175], v[180:183]
    v_cvt_pk_bf16_f32 v249, v170, v171
    v_cvt_pk_bf16_f32 v197, v194, v195
    v_smfmac_f32_16x16x64_bf16 v[234:237], a[252:255], v[184:191], v202
    buffer_load_dwordx4 v223, s[8:11], s38 offen offset:3072 nt lds
    v_mfma_f32_16x16x32_bf16 v[40:43], v[184:187], a[72:75], v[40:43]
    v_exp_f32 v172, v172
    v_mfma_f32_16x16x32_bf16 v[40:43], v[188:191], a[104:107], v[40:43]
    v_mfma_f32_16x16x32_bf16 v[44:47], v[188:191], a[108:111], v[44:47]
    v_exp_f32 v173, v173
    v_mfma_f32_16x16x32_bf16 v[44:47], v[184:187], a[76:79], v[44:47]
    v_cvt_pk_bf16_f32 v250, v172, v173
    v_mfma_f32_16x16x32_bf16 v[48:51], v[184:187], a[80:83], v[48:51]
    v_exp_f32 v174, v174
    v_mfma_f32_16x16x32_bf16 v[48:51], v[188:191], a[112:115], v[48:51]
    v_mfma_f32_16x16x32_bf16 v[52:55], v[188:191], a[116:119], v[52:55]
    v_exp_f32 v175, v175
    v_mfma_f32_16x16x32_bf16 v[52:55], v[184:187], a[84:87], v[52:55]
    v_cvt_pk_bf16_f32 v251, v174, v175
    v_mfma_f32_16x16x32_bf16 v[56:59], v[184:187], a[88:91], v[56:59]
    v_exp_f32 v176, v176
    v_mfma_f32_16x16x32_bf16 v[56:59], v[188:191], a[120:123], v[56:59]
    v_mfma_f32_16x16x32_bf16 v[60:63], v[188:191], a[124:127], v[60:63]
    v_exp_f32 v177, v177
    v_mfma_f32_16x16x32_bf16 v[60:63], v[184:187], a[92:95], v[60:63]
    v_cvt_pk_bf16_f32 v252, v176, v177
    v_mfma_f32_16x16x32_bf16 v[32:35], v[184:187], a[64:67], v[32:35]
    v_exp_f32 v178, v178
    s_add_u32 m0, s22, 114688
    v_mfma_f32_16x16x32_bf16 v[32:35], v[188:191], a[96:99], v[32:35]
    buffer_load_dwordx4 v224, s[12:15], s38 offen nt lds
    v_mfma_f32_16x16x32_bf16 v[36:39], v[188:191], a[100:103], v[36:39]
    v_exp_f32 v179, v179
    v_mfma_f32_16x16x32_bf16 v[36:39], v[184:187], a[68:71], v[36:39]
    v_cvt_pk_bf16_f32 v253, v178, v179
    v_mfma_f32_16x16x32_bf16 v[168:171], a[0:3], a[176:179], 0
    v_exp_f32 v180, v180
    v_mfma_f32_16x16x32_bf16 v[168:171], a[4:7], a[180:183], v[168:171]
    v_mfma_f32_16x16x32_bf16 v[168:171], a[8:11], a[184:187], v[168:171]
    v_exp_f32 v181, v181
    v_mfma_f32_16x16x32_bf16 v[168:171], a[12:15], a[188:191], v[168:171]
    v_cvt_pk_bf16_f32 v254, v180, v181
    v_mfma_f32_16x16x32_bf16 v[172:175], a[16:19], a[176:179], 0
    v_exp_f32 v182, v182
    v_mfma_f32_16x16x32_bf16 v[172:175], a[20:23], a[180:183], v[172:175]
    v_mfma_f32_16x16x32_bf16 v[172:175], a[24:27], a[184:187], v[172:175]
    v_exp_f32 v183, v183
    v_mfma_f32_16x16x32_bf16 v[172:175], a[28:31], a[188:191], v[172:175]
    v_cvt_pk_bf16_f32 v255, v182, v183
    v_mfma_f32_16x16x32_bf16 v[176:179], a[32:35], a[176:179], 0
    v_exp_f32 v168, v168
    v_mfma_f32_16x16x32_bf16 v[176:179], a[36:39], a[180:183], v[176:179]
    buffer_load_dwordx4 v225, s[12:15], s38 offen offset:1024 nt lds
    v_mfma_f32_16x16x32_bf16 v[176:179], a[40:43], a[184:187], v[176:179]
    v_exp_f32 v169, v169
    v_mfma_f32_16x16x32_bf16 v[176:179], a[44:47], a[188:191], v[176:179]
    v_cvt_pk_bf16_f32 v184, v168, v169
    v_mfma_f32_16x16x32_bf16 v[180:183], a[48:51], a[176:179], 0
    v_exp_f32 v170, v170
    v_mfma_f32_16x16x32_bf16 v[180:183], a[52:55], a[180:183], v[180:183]
    v_mfma_f32_16x16x32_bf16 v[180:183], a[56:59], a[184:187], v[180:183]
    v_exp_f32 v171, v171
    v_mfma_f32_16x16x32_bf16 v[180:183], a[60:63], a[188:191], v[180:183]
    v_cvt_pk_bf16_f32 v185, v170, v171
    v_smfmac_f32_16x16x64_bf16 v[238:241], a[248:251], v[248:255], v202
    v_mfma_f32_16x16x32_bf16 v[72:75], v[248:251], a[72:75], v[72:75]
    v_exp_f32 v172, v172
    v_mfma_f32_16x16x32_bf16 v[72:75], v[252:255], a[104:107], v[72:75]
    v_mfma_f32_16x16x32_bf16 v[76:79], v[252:255], a[108:111], v[76:79]
    v_exp_f32 v173, v173
    v_mfma_f32_16x16x32_bf16 v[76:79], v[248:251], a[76:79], v[76:79]
    v_cvt_pk_bf16_f32 v186, v172, v173
    v_mfma_f32_16x16x32_bf16 v[80:83], v[248:251], a[80:83], v[80:83]
    v_exp_f32 v174, v174
    v_mfma_f32_16x16x32_bf16 v[80:83], v[252:255], a[112:115], v[80:83]
    v_mfma_f32_16x16x32_bf16 v[84:87], v[252:255], a[116:119], v[84:87]
    v_exp_f32 v175, v175
    v_mfma_f32_16x16x32_bf16 v[84:87], v[248:251], a[84:87], v[84:87]
    v_cvt_pk_bf16_f32 v187, v174, v175
    v_mfma_f32_16x16x32_bf16 v[88:91], v[248:251], a[88:91], v[88:91]
    v_exp_f32 v176, v176
    v_mfma_f32_16x16x32_bf16 v[88:91], v[252:255], a[120:123], v[88:91]
    v_mfma_f32_16x16x32_bf16 v[92:95], v[252:255], a[124:127], v[92:95]
    v_exp_f32 v177, v177
    v_mfma_f32_16x16x32_bf16 v[92:95], v[248:251], a[92:95], v[92:95]
    v_cvt_pk_bf16_f32 v188, v176, v177
    v_mfma_f32_16x16x32_bf16 v[64:67], v[248:251], a[64:67], v[64:67]
    ds_write_b64 v226, v[196:197] offset:2048
    v_exp_f32 v178, v178
    v_mfma_f32_16x16x32_bf16 v[64:67], v[252:255], a[96:99], v[64:67]
    v_mfma_f32_16x16x32_bf16 v[68:71], v[252:255], a[100:103], v[68:71]
    v_exp_f32 v179, v179
    v_mfma_f32_16x16x32_bf16 v[68:71], v[248:251], a[68:71], v[68:71]
    v_cvt_pk_bf16_f32 v189, v178, v179
    s_waitcnt vmcnt(10) lgkmcnt(0)
    s_barrier
    v_mfma_f32_16x16x32_bf16 v[168:171], a[0:3], a[192:195], 0
    v_exp_f32 v180, v180
    v_mfma_f32_16x16x32_bf16 v[168:171], a[4:7], a[196:199], v[168:171]
    ds_read_b128 a[224:227], v216 offset:32768
    v_mfma_f32_16x16x32_bf16 v[168:171], a[8:11], a[200:203], v[168:171]
    v_exp_f32 v181, v181
    v_mfma_f32_16x16x32_bf16 v[168:171], a[12:15], a[204:207], v[168:171]
    ds_read_b128 a[228:231], v217 offset:32768
    v_cvt_pk_bf16_f32 v190, v180, v181
    v_mfma_f32_16x16x32_bf16 v[172:175], a[16:19], a[192:195], 0
    v_exp_f32 v182, v182
    v_mfma_f32_16x16x32_bf16 v[172:175], a[20:23], a[196:199], v[172:175]
    ds_read_b128 a[232:235], v218 offset:32768
    v_mfma_f32_16x16x32_bf16 v[172:175], a[24:27], a[200:203], v[172:175]
    v_exp_f32 v183, v183
    v_mfma_f32_16x16x32_bf16 v[172:175], a[28:31], a[204:207], v[172:175]
    ds_read_b128 a[236:239], v219 offset:32768
    v_cvt_pk_bf16_f32 v191, v182, v183
    v_mfma_f32_16x16x32_bf16 v[176:179], a[32:35], a[192:195], 0
    v_exp_f32 v168, v168
    v_mfma_f32_16x16x32_bf16 v[176:179], a[36:39], a[196:199], v[176:179]
    buffer_load_dwordx4 v224, s[12:15], s38 offen offset:2048 nt lds
    v_mfma_f32_16x16x32_bf16 v[176:179], a[40:43], a[200:203], v[176:179]
    v_exp_f32 v169, v169
    v_mfma_f32_16x16x32_bf16 v[176:179], a[44:47], a[204:207], v[176:179]
    ds_read_b128 a[0:3], v204 offset:32768
    v_cvt_pk_bf16_f32 v248, v168, v169
    v_mfma_f32_16x16x32_bf16 v[180:183], a[48:51], a[192:195], 0
    v_exp_f32 v170, v170
    v_mfma_f32_16x16x32_bf16 v[180:183], a[52:55], a[196:199], v[180:183]
    ds_read_b128 a[4:7], v205 offset:32768
    v_mfma_f32_16x16x32_bf16 v[180:183], a[56:59], a[200:203], v[180:183]
    v_exp_f32 v171, v171
    v_mfma_f32_16x16x32_bf16 v[180:183], a[60:63], a[204:207], v[180:183]
    ds_read_b128 a[8:11], v206 offset:32768
    v_cvt_pk_bf16_f32 v249, v170, v171
    v_smfmac_f32_16x16x64_bf16 v[238:241], a[252:255], v[184:191], v202
    ds_read_b128 a[12:15], v207 offset:32768
    v_mfma_f32_16x16x32_bf16 v[104:107], v[184:187], a[72:75], v[104:107]
    v_exp_f32 v172, v172
    v_mfma_f32_16x16x32_bf16 v[104:107], v[188:191], a[104:107], v[104:107]
    ds_read_b128 a[16:19], v204 offset:36864
    v_mfma_f32_16x16x32_bf16 v[108:111], v[188:191], a[108:111], v[108:111]
    v_exp_f32 v173, v173
    v_mfma_f32_16x16x32_bf16 v[108:111], v[184:187], a[76:79], v[108:111]
    ds_read_b128 a[20:23], v205 offset:36864
    v_cvt_pk_bf16_f32 v250, v172, v173
    v_mfma_f32_16x16x32_bf16 v[112:115], v[184:187], a[80:83], v[112:115]
    v_exp_f32 v174, v174
    v_mfma_f32_16x16x32_bf16 v[112:115], v[188:191], a[112:115], v[112:115]
    ds_read_b128 a[24:27], v206 offset:36864
    v_mfma_f32_16x16x32_bf16 v[116:119], v[188:191], a[116:119], v[116:119]
    v_exp_f32 v175, v175
    v_mfma_f32_16x16x32_bf16 v[116:119], v[184:187], a[84:87], v[116:119]
    ds_read_b128 a[28:31], v207 offset:36864
    v_cvt_pk_bf16_f32 v251, v174, v175
    v_mfma_f32_16x16x32_bf16 v[120:123], v[184:187], a[88:91], v[120:123]
    v_exp_f32 v176, v176
    v_mfma_f32_16x16x32_bf16 v[120:123], v[188:191], a[120:123], v[120:123]
    ds_read_b128 a[32:35], v204 offset:40960
    v_mfma_f32_16x16x32_bf16 v[124:127], v[188:191], a[124:127], v[124:127]
    v_exp_f32 v177, v177
    v_mfma_f32_16x16x32_bf16 v[124:127], v[184:187], a[92:95], v[124:127]
    ds_read_b128 a[36:39], v205 offset:40960
    v_cvt_pk_bf16_f32 v252, v176, v177
    v_mfma_f32_16x16x32_bf16 v[96:99], v[184:187], a[64:67], v[96:99]
    v_exp_f32 v178, v178
    v_mfma_f32_16x16x32_bf16 v[96:99], v[188:191], a[96:99], v[96:99]
    ds_read_b128 a[40:43], v206 offset:40960
    v_mfma_f32_16x16x32_bf16 v[100:103], v[188:191], a[100:103], v[100:103]
    v_exp_f32 v179, v179
    v_mfma_f32_16x16x32_bf16 v[100:103], v[184:187], a[68:71], v[100:103]
    s_waitcnt lgkmcnt(3)
    ds_read_b128 a[44:47], v207 offset:40960
    v_cvt_pk_bf16_f32 v253, v178, v179
    v_mfma_f32_16x16x32_bf16 v[192:195], a[224:227], a[208:211], 0
    ds_read_b128 a[48:51], v204 offset:45056
    v_mfma_f32_16x16x32_bf16 v[192:195], a[228:231], a[212:215], v[192:195]
    ds_read_b128 a[52:55], v205 offset:45056
    v_mfma_f32_16x16x32_bf16 v[192:195], a[232:235], a[216:219], v[192:195]
    ds_read_b128 a[56:59], v206 offset:45056
    v_mfma_f32_16x16x32_bf16 v[192:195], a[236:239], a[220:223], v[192:195]
    buffer_load_dwordx4 v225, s[12:15], s38 offen offset:3072 nt lds
    v_mfma_f32_16x16x32_bf16 v[168:171], a[0:3], a[128:131], 0
    v_exp_f32 v180, v180
    v_mfma_f32_16x16x32_bf16 v[168:171], a[4:7], a[132:135], v[168:171]
    ds_read_b128 a[60:63], v207 offset:45056
    v_mfma_f32_16x16x32_bf16 v[168:171], a[8:11], a[136:139], v[168:171]
    v_exp_f32 v181, v181
    v_mfma_f32_16x16x32_bf16 v[168:171], a[12:15], a[140:143], v[168:171]
    ds_read_b128 a[240:243], v227 offset:2048
    v_cvt_pk_bf16_f32 v254, v180, v181
    v_mfma_f32_16x16x32_bf16 v[172:175], a[16:19], a[128:131], 0
    v_exp_f32 v182, v182
    s_add_u32 s21, s22, 65536
    s_add_u32 m0, s22, 0
    v_mfma_f32_16x16x32_bf16 v[172:175], a[20:23], a[132:135], v[172:175]
    buffer_load_dwordx4 v220, s[8:11], s21 offen nt lds
    v_mfma_f32_16x16x32_bf16 v[172:175], a[24:27], a[136:139], v[172:175]
    v_exp_f32 v183, v183
    v_mfma_f32_16x16x32_bf16 v[172:175], a[28:31], a[140:143], v[172:175]
    s_waitcnt lgkmcnt(1)
    ds_read_b128 a[244:247], v227 offset:3072
    v_cvt_pk_bf16_f32 v255, v182, v183
    v_mfma_f32_16x16x32_bf16 v[176:179], a[32:35], a[128:131], 0
    v_exp_f32 v168, v168
    v_mfma_f32_16x16x32_bf16 v[176:179], a[36:39], a[132:135], v[176:179]
    v_mfma_f32_16x16x32_bf16 v[176:179], a[40:43], a[136:139], v[176:179]
    v_exp_f32 v169, v169
    v_mfma_f32_16x16x32_bf16 v[176:179], a[44:47], a[140:143], v[176:179]
    v_cvt_pk_bf16_f32 v184, v168, v169
    v_mfma_f32_16x16x32_bf16 v[180:183], a[48:51], a[128:131], 0
    v_exp_f32 v170, v170
    v_mfma_f32_16x16x32_bf16 v[180:183], a[52:55], a[132:135], v[180:183]
    buffer_load_dwordx4 v221, s[8:11], s21 offen offset:1024 nt lds
    v_mfma_f32_16x16x32_bf16 v[180:183], a[56:59], a[136:139], v[180:183]
    v_exp_f32 v171, v171
    v_mfma_f32_16x16x32_bf16 v[180:183], a[60:63], a[140:143], v[180:183]
    v_cvt_pk_bf16_f32 v185, v170, v171
    s_waitcnt vmcnt(10)
    s_barrier
    v_smfmac_f32_16x16x64_bf16 v[230:233], a[248:251], v[248:255], v202
    v_mfma_f32_16x16x32_bf16 v[136:139], v[248:251], a[72:75], v[136:139]
    v_exp_f32 v172, v172
    v_mfma_f32_16x16x32_bf16 v[136:139], v[252:255], a[104:107], v[136:139]
    ds_read_b64_tr_b16 a[72:73], v210 offset:32768
    ds_read_b64_tr_b16 a[74:75], v210 offset:36864
    v_mfma_f32_16x16x32_bf16 v[140:143], v[252:255], a[108:111], v[140:143]
    v_exp_f32 v173, v173
    v_mfma_f32_16x16x32_bf16 v[140:143], v[248:251], a[76:79], v[140:143]
    ds_read_b64_tr_b16 a[104:105], v210 offset:40960
    v_cvt_pk_bf16_f32 v186, v172, v173
    v_mfma_f32_16x16x32_bf16 v[144:147], v[248:251], a[80:83], v[144:147]
    v_exp_f32 v174, v174
    v_mfma_f32_16x16x32_bf16 v[144:147], v[252:255], a[112:115], v[144:147]
    ds_read_b64_tr_b16 a[106:107], v210 offset:45056
    ds_read_b64_tr_b16 a[108:109], v211 offset:40960
    v_mfma_f32_16x16x32_bf16 v[148:151], v[252:255], a[116:119], v[148:151]
    v_exp_f32 v175, v175
    v_mfma_f32_16x16x32_bf16 v[148:151], v[248:251], a[84:87], v[148:151]
    ds_read_b64_tr_b16 a[110:111], v211 offset:45056
    v_cvt_pk_bf16_f32 v187, v174, v175
    v_mfma_f32_16x16x32_bf16 v[152:155], v[248:251], a[88:91], v[152:155]
    v_exp_f32 v176, v176
    v_mfma_f32_16x16x32_bf16 v[152:155], v[252:255], a[120:123], v[152:155]
    ds_read_b64_tr_b16 a[76:77], v211 offset:32768
    ds_read_b64_tr_b16 a[78:79], v211 offset:36864
    v_mfma_f32_16x16x32_bf16 v[156:159], v[252:255], a[124:127], v[156:159]
    v_exp_f32 v177, v177
    v_mfma_f32_16x16x32_bf16 v[156:159], v[248:251], a[92:95], v[156:159]
    ds_read_b64_tr_b16 a[80:81], v212 offset:32768
    v_cvt_pk_bf16_f32 v188, v176, v177
    v_mfma_f32_16x16x32_bf16 v[128:131], v[248:251], a[64:67], v[128:131]
    v_exp_f32 v178, v178
    v_mfma_f32_16x16x32_bf16 v[128:131], v[252:255], a[96:99], v[128:131]
    ds_read_b64_tr_b16 a[82:83], v212 offset:36864
    ds_read_b64_tr_b16 a[112:113], v212 offset:40960
    v_mfma_f32_16x16x32_bf16 v[132:135], v[252:255], a[100:103], v[132:135]
    v_exp_f32 v179, v179
    v_mfma_f32_16x16x32_bf16 v[132:135], v[248:251], a[68:71], v[132:135]
    s_waitcnt lgkmcnt(4)
    ds_read_b64_tr_b16 a[114:115], v212 offset:45056
    v_cvt_pk_bf16_f32 v189, v178, v179
    v_smfmac_f32_16x16x64_bf16 v[230:233], a[252:255], a[240:247], v202
    ds_read_b64_tr_b16 a[116:117], v213 offset:40960
    ds_read_b64_tr_b16 a[118:119], v213 offset:45056
    v_mfma_f32_16x16x32_bf16 v[160:163], a[240:243], a[64:67], v[160:163]
    ds_read_b64_tr_b16 a[84:85], v213 offset:32768
    ds_read_b64_tr_b16 a[86:87], v213 offset:36864
    v_mfma_f32_16x16x32_bf16 v[160:163], a[244:247], a[96:99], v[160:163]
    buffer_load_dwordx4 v222, s[8:11], s21 offen offset:2048 nt lds
    v_mfma_f32_16x16x32_bf16 v[164:167], a[244:247], a[100:103], v[164:167]
    ds_read_b64_tr_b16 a[88:89], v214 offset:32768
    ds_read_b64_tr_b16 a[90:91], v214 offset:36864
    v_mfma_f32_16x16x32_bf16 v[164:167], a[240:243], a[68:71], v[164:167]
    ds_read_b64_tr_b16 a[120:121], v214 offset:40960
    ds_read_b64_tr_b16 a[122:123], v214 offset:45056
    v_mfma_f32_16x16x32_bf16 v[168:171], a[0:3], a[144:147], 0
    v_exp_f32 v180, v180
    v_mfma_f32_16x16x32_bf16 v[168:171], a[4:7], a[148:151], v[168:171]
    ds_read_b64_tr_b16 a[124:125], v215 offset:40960
    ds_read_b64_tr_b16 a[126:127], v215 offset:45056
    v_mfma_f32_16x16x32_bf16 v[168:171], a[8:11], a[152:155], v[168:171]
    v_exp_f32 v181, v181
    v_mfma_f32_16x16x32_bf16 v[168:171], a[12:15], a[156:159], v[168:171]
    ds_read_b64_tr_b16 a[92:93], v215 offset:32768
    v_cvt_pk_bf16_f32 v190, v180, v181
    v_mfma_f32_16x16x32_bf16 v[172:175], a[16:19], a[144:147], 0
    v_exp_f32 v182, v182
    v_mfma_f32_16x16x32_bf16 v[172:175], a[20:23], a[148:151], v[172:175]
    ds_read_b64_tr_b16 a[94:95], v215 offset:36864
    ds_read_b64_tr_b16 a[64:65], v208 offset:32768
    v_mfma_f32_16x16x32_bf16 v[172:175], a[24:27], a[152:155], v[172:175]
    v_exp_f32 v183, v183
    v_mfma_f32_16x16x32_bf16 v[172:175], a[28:31], a[156:159], v[172:175]
    ds_read_b64_tr_b16 a[66:67], v208 offset:36864
    v_cvt_pk_bf16_f32 v191, v182, v183
    v_mfma_f32_16x16x32_bf16 v[176:179], a[32:35], a[144:147], 0
    v_exp_f32 v168, v168
    v_mfma_f32_16x16x32_bf16 v[176:179], a[36:39], a[148:151], v[176:179]
    ds_read_b64_tr_b16 a[96:97], v208 offset:40960
    ds_read_b64_tr_b16 a[98:99], v208 offset:45056
    v_mfma_f32_16x16x32_bf16 v[176:179], a[40:43], a[152:155], v[176:179]
    v_exp_f32 v169, v169
    v_mfma_f32_16x16x32_bf16 v[176:179], a[44:47], a[156:159], v[176:179]
    ds_read_b64_tr_b16 a[100:101], v209 offset:40960
    v_cvt_pk_bf16_f32 v248, v168, v169
    v_mfma_f32_16x16x32_bf16 v[180:183], a[48:51], a[144:147], 0
    v_exp_f32 v170, v170
    v_mfma_f32_16x16x32_bf16 v[180:183], a[52:55], a[148:151], v[180:183]
    ds_read_b64_tr_b16 a[102:103], v209 offset:45056
    ds_read_b64_tr_b16 a[68:69], v209 offset:32768
    v_mfma_f32_16x16x32_bf16 v[180:183], a[56:59], a[152:155], v[180:183]
    v_exp_f32 v171, v171
    v_mfma_f32_16x16x32_bf16 v[180:183], a[60:63], a[156:159], v[180:183]
    ds_read_b64_tr_b16 a[70:71], v209 offset:36864
    v_cvt_pk_bf16_f32 v249, v170, v171
    v_smfmac_f32_16x16x64_bf16 v[234:237], a[248:251], v[184:191], v202
    buffer_load_dwordx4 v223, s[8:11], s21 offen offset:3072 nt lds
    v_mfma_f32_16x16x32_bf16 v[8:11], v[184:187], a[72:75], v[8:11]
    v_exp_f32 v172, v172
    v_mfma_f32_16x16x32_bf16 v[8:11], v[188:191], a[104:107], v[8:11]
    v_exp_f32 v192, v192
    v_mfma_f32_16x16x32_bf16 v[12:15], v[188:191], a[108:111], v[12:15]
    s_waitcnt lgkmcnt(3)
    v_exp_f32 v173, v173
    v_mfma_f32_16x16x32_bf16 v[12:15], v[184:187], a[76:79], v[12:15]
    v_cvt_pk_bf16_f32 v250, v172, v173
    v_mfma_f32_16x16x32_bf16 v[16:19], v[184:187], a[80:83], v[16:19]
    v_exp_f32 v174, v174
    s_add_u32 m0, s22, 65536
    v_mfma_f32_16x16x32_bf16 v[16:19], v[188:191], a[112:115], v[16:19]
    buffer_load_dwordx4 v224, s[12:15], s21 offen nt lds
    v_mfma_f32_16x16x32_bf16 v[20:23], v[188:191], a[116:119], v[20:23]
    v_exp_f32 v175, v175
    v_mfma_f32_16x16x32_bf16 v[20:23], v[184:187], a[84:87], v[20:23]
    v_cvt_pk_bf16_f32 v251, v174, v175
    v_mfma_f32_16x16x32_bf16 v[24:27], v[184:187], a[88:91], v[24:27]
    v_exp_f32 v176, v176
    v_mfma_f32_16x16x32_bf16 v[24:27], v[188:191], a[120:123], v[24:27]
    v_exp_f32 v193, v193
    v_mfma_f32_16x16x32_bf16 v[28:31], v[188:191], a[124:127], v[28:31]
    v_exp_f32 v177, v177
    v_mfma_f32_16x16x32_bf16 v[28:31], v[184:187], a[92:95], v[28:31]
    v_cvt_pk_bf16_f32 v252, v176, v177
    v_cvt_pk_bf16_f32 v196, v192, v193
    v_mfma_f32_16x16x32_bf16 v[0:3], v[184:187], a[64:67], v[0:3]
    v_exp_f32 v178, v178
    v_mfma_f32_16x16x32_bf16 v[0:3], v[188:191], a[96:99], v[0:3]
    s_waitcnt lgkmcnt(0)
    v_exp_f32 v194, v194
    v_mfma_f32_16x16x32_bf16 v[4:7], v[188:191], a[100:103], v[4:7]
    v_exp_f32 v179, v179
    v_mfma_f32_16x16x32_bf16 v[4:7], v[184:187], a[68:71], v[4:7]
    v_cvt_pk_bf16_f32 v253, v178, v179
    v_mfma_f32_16x16x32_bf16 v[168:171], a[0:3], a[160:163], 0
    v_exp_f32 v180, v180
    v_mfma_f32_16x16x32_bf16 v[168:171], a[4:7], a[164:167], v[168:171]
    v_exp_f32 v195, v195
    v_mfma_f32_16x16x32_bf16 v[168:171], a[8:11], a[168:171], v[168:171]
    v_exp_f32 v181, v181
    v_mfma_f32_16x16x32_bf16 v[168:171], a[12:15], a[172:175], v[168:171]
    v_cvt_pk_bf16_f32 v254, v180, v181
    v_cvt_pk_bf16_f32 v197, v194, v195
    v_mfma_f32_16x16x32_bf16 v[172:175], a[16:19], a[160:163], 0
    v_exp_f32 v182, v182
    v_mfma_f32_16x16x32_bf16 v[172:175], a[20:23], a[164:167], v[172:175]
    buffer_load_dwordx4 v225, s[12:15], s21 offen offset:1024 nt lds
    v_mfma_f32_16x16x32_bf16 v[172:175], a[24:27], a[168:171], v[172:175]
    v_exp_f32 v183, v183
    v_mfma_f32_16x16x32_bf16 v[172:175], a[28:31], a[172:175], v[172:175]
    v_cvt_pk_bf16_f32 v255, v182, v183
    v_mfma_f32_16x16x32_bf16 v[176:179], a[32:35], a[160:163], 0
    v_exp_f32 v168, v168
    v_mfma_f32_16x16x32_bf16 v[176:179], a[36:39], a[164:167], v[176:179]
    v_mfma_f32_16x16x32_bf16 v[176:179], a[40:43], a[168:171], v[176:179]
    v_exp_f32 v169, v169
    v_mfma_f32_16x16x32_bf16 v[176:179], a[44:47], a[172:175], v[176:179]
    v_cvt_pk_bf16_f32 v184, v168, v169
    v_mfma_f32_16x16x32_bf16 v[180:183], a[48:51], a[160:163], 0
    v_exp_f32 v170, v170
    v_mfma_f32_16x16x32_bf16 v[180:183], a[52:55], a[164:167], v[180:183]
    v_mfma_f32_16x16x32_bf16 v[180:183], a[56:59], a[168:171], v[180:183]
    v_exp_f32 v171, v171
    v_mfma_f32_16x16x32_bf16 v[180:183], a[60:63], a[172:175], v[180:183]
    v_cvt_pk_bf16_f32 v185, v170, v171
    v_smfmac_f32_16x16x64_bf16 v[234:237], a[252:255], v[248:255], v202
    v_mfma_f32_16x16x32_bf16 v[40:43], v[248:251], a[72:75], v[40:43]
    v_exp_f32 v172, v172
    v_mfma_f32_16x16x32_bf16 v[40:43], v[252:255], a[104:107], v[40:43]
    v_mfma_f32_16x16x32_bf16 v[44:47], v[252:255], a[108:111], v[44:47]
    v_exp_f32 v173, v173
    v_mfma_f32_16x16x32_bf16 v[44:47], v[248:251], a[76:79], v[44:47]
    v_cvt_pk_bf16_f32 v186, v172, v173
    v_mfma_f32_16x16x32_bf16 v[48:51], v[248:251], a[80:83], v[48:51]
    v_exp_f32 v174, v174
    v_mfma_f32_16x16x32_bf16 v[48:51], v[252:255], a[112:115], v[48:51]
    buffer_load_dwordx4 v224, s[12:15], s21 offen offset:2048 nt lds
    v_mfma_f32_16x16x32_bf16 v[52:55], v[252:255], a[116:119], v[52:55]
    v_exp_f32 v175, v175
    v_mfma_f32_16x16x32_bf16 v[52:55], v[248:251], a[84:87], v[52:55]
    v_cvt_pk_bf16_f32 v187, v174, v175
    v_mfma_f32_16x16x32_bf16 v[56:59], v[248:251], a[88:91], v[56:59]
    v_exp_f32 v176, v176
    v_mfma_f32_16x16x32_bf16 v[56:59], v[252:255], a[120:123], v[56:59]
    v_mfma_f32_16x16x32_bf16 v[60:63], v[252:255], a[124:127], v[60:63]
    v_exp_f32 v177, v177
    v_mfma_f32_16x16x32_bf16 v[60:63], v[248:251], a[92:95], v[60:63]
    v_cvt_pk_bf16_f32 v188, v176, v177
    v_mfma_f32_16x16x32_bf16 v[32:35], v[248:251], a[64:67], v[32:35]
    v_exp_f32 v178, v178
    v_mfma_f32_16x16x32_bf16 v[32:35], v[252:255], a[96:99], v[32:35]
    v_mfma_f32_16x16x32_bf16 v[36:39], v[252:255], a[100:103], v[36:39]
    v_exp_f32 v179, v179
    v_mfma_f32_16x16x32_bf16 v[36:39], v[248:251], a[68:71], v[36:39]
    v_cvt_pk_bf16_f32 v189, v178, v179
    v_mfma_f32_16x16x32_bf16 v[168:171], a[0:3], a[176:179], 0
    v_exp_f32 v180, v180
    v_mfma_f32_16x16x32_bf16 v[168:171], a[4:7], a[180:183], v[168:171]
    v_mfma_f32_16x16x32_bf16 v[168:171], a[8:11], a[184:187], v[168:171]
    v_exp_f32 v181, v181
    v_mfma_f32_16x16x32_bf16 v[168:171], a[12:15], a[188:191], v[168:171]
    v_cvt_pk_bf16_f32 v190, v180, v181
    v_mfma_f32_16x16x32_bf16 v[172:175], a[16:19], a[176:179], 0
    v_exp_f32 v182, v182
    v_mfma_f32_16x16x32_bf16 v[172:175], a[20:23], a[180:183], v[172:175]
    buffer_load_dwordx4 v225, s[12:15], s21 offen offset:3072 nt lds
    v_mfma_f32_16x16x32_bf16 v[172:175], a[24:27], a[184:187], v[172:175]
    v_exp_f32 v183, v183
    v_mfma_f32_16x16x32_bf16 v[172:175], a[28:31], a[188:191], v[172:175]
    v_cvt_pk_bf16_f32 v191, v182, v183
    v_mfma_f32_16x16x32_bf16 v[176:179], a[32:35], a[176:179], 0
    v_exp_f32 v168, v168
    v_mfma_f32_16x16x32_bf16 v[176:179], a[36:39], a[180:183], v[176:179]
    v_mfma_f32_16x16x32_bf16 v[176:179], a[40:43], a[184:187], v[176:179]
    v_exp_f32 v169, v169
    v_mfma_f32_16x16x32_bf16 v[176:179], a[44:47], a[188:191], v[176:179]
    v_cvt_pk_bf16_f32 v248, v168, v169
    v_mfma_f32_16x16x32_bf16 v[180:183], a[48:51], a[176:179], 0
    v_exp_f32 v170, v170
    v_mfma_f32_16x16x32_bf16 v[180:183], a[52:55], a[180:183], v[180:183]
    v_mfma_f32_16x16x32_bf16 v[180:183], a[56:59], a[184:187], v[180:183]
    v_exp_f32 v171, v171
    v_mfma_f32_16x16x32_bf16 v[180:183], a[60:63], a[188:191], v[180:183]
    v_cvt_pk_bf16_f32 v249, v170, v171
    v_smfmac_f32_16x16x64_bf16 v[238:241], a[248:251], v[184:191], v202
    v_mfma_f32_16x16x32_bf16 v[72:75], v[184:187], a[72:75], v[72:75]
    v_exp_f32 v172, v172
    v_mfma_f32_16x16x32_bf16 v[72:75], v[188:191], a[104:107], v[72:75]
    v_mfma_f32_16x16x32_bf16 v[76:79], v[188:191], a[108:111], v[76:79]
    v_exp_f32 v173, v173
    v_mfma_f32_16x16x32_bf16 v[76:79], v[184:187], a[76:79], v[76:79]
    v_cvt_pk_bf16_f32 v250, v172, v173
    v_mfma_f32_16x16x32_bf16 v[80:83], v[184:187], a[80:83], v[80:83]
    v_exp_f32 v174, v174
    v_mfma_f32_16x16x32_bf16 v[80:83], v[188:191], a[112:115], v[80:83]
    v_mfma_f32_16x16x32_bf16 v[84:87], v[188:191], a[116:119], v[84:87]
    v_exp_f32 v175, v175
    v_mfma_f32_16x16x32_bf16 v[84:87], v[184:187], a[84:87], v[84:87]
    v_cvt_pk_bf16_f32 v251, v174, v175
    v_mfma_f32_16x16x32_bf16 v[88:91], v[184:187], a[88:91], v[88:91]
    v_exp_f32 v176, v176
    v_mfma_f32_16x16x32_bf16 v[88:91], v[188:191], a[120:123], v[88:91]
    v_mfma_f32_16x16x32_bf16 v[92:95], v[188:191], a[124:127], v[92:95]
    v_exp_f32 v177, v177
    v_mfma_f32_16x16x32_bf16 v[92:95], v[184:187], a[92:95], v[92:95]
    v_cvt_pk_bf16_f32 v252, v176, v177
    v_mfma_f32_16x16x32_bf16 v[64:67], v[184:187], a[64:67], v[64:67]
    ds_write_b64 v226, v[196:197] offset:0
    v_exp_f32 v178, v178
    v_mfma_f32_16x16x32_bf16 v[64:67], v[188:191], a[96:99], v[64:67]
    v_mfma_f32_16x16x32_bf16 v[68:71], v[188:191], a[100:103], v[68:71]
    v_exp_f32 v179, v179
    v_mfma_f32_16x16x32_bf16 v[68:71], v[184:187], a[68:71], v[68:71]
    v_cvt_pk_bf16_f32 v253, v178, v179
    s_add_u32 s21, s21, 16384
    s_waitcnt vmcnt(8) lgkmcnt(0)
    s_barrier
L_loop:
    v_mfma_f32_16x16x32_bf16 v[168:171], a[0:3], a[192:195], 0
    v_exp_f32 v180, v180
    v_mfma_f32_16x16x32_bf16 v[168:171], a[4:7], a[196:199], v[168:171]
    ds_read_b128 a[224:227], v216 offset:49152
    v_mfma_f32_16x16x32_bf16 v[168:171], a[8:11], a[200:203], v[168:171]
    v_exp_f32 v181, v181
    v_mfma_f32_16x16x32_bf16 v[168:171], a[12:15], a[204:207], v[168:171]
    ds_read_b128 a[228:231], v217 offset:49152
    v_cvt_pk_bf16_f32 v254, v180, v181
    v_mfma_f32_16x16x32_bf16 v[172:175], a[16:19], a[192:195], 0
    v_exp_f32 v182, v182
    v_mfma_f32_16x16x32_bf16 v[172:175], a[20:23], a[196:199], v[172:175]
    ds_read_b128 a[232:235], v218 offset:49152
    v_mfma_f32_16x16x32_bf16 v[172:175], a[24:27], a[200:203], v[172:175]
    v_exp_f32 v183, v183
    v_mfma_f32_16x16x32_bf16 v[172:175], a[28:31], a[204:207], v[172:175]
    ds_read_b128 a[236:239], v219 offset:49152
    v_cvt_pk_bf16_f32 v255, v182, v183
    v_mfma_f32_16x16x32_bf16 v[176:179], a[32:35], a[192:195], 0
    v_exp_f32 v168, v168
    v_mfma_f32_16x16x32_bf16 v[176:179], a[36:39], a[196:199], v[176:179]
    ds_read_b128 a[0:3], v204 offset:49152
    v_mfma_f32_16x16x32_bf16 v[176:179], a[40:43], a[200:203], v[176:179]
    v_exp_f32 v169, v169
    v_mfma_f32_16x16x32_bf16 v[176:179], a[44:47], a[204:207], v[176:179]
    ds_read_b128 a[4:7], v205 offset:49152
    v_cvt_pk_bf16_f32 v184, v168, v169
    v_mfma_f32_16x16x32_bf16 v[180:183], a[48:51], a[192:195], 0
    v_exp_f32 v170, v170
    v_mfma_f32_16x16x32_bf16 v[180:183], a[52:55], a[196:199], v[180:183]
    ds_read_b128 a[8:11], v206 offset:49152
    v_mfma_f32_16x16x32_bf16 v[180:183], a[56:59], a[200:203], v[180:183]
    v_exp_f32 v171, v171
    v_mfma_f32_16x16x32_bf16 v[180:183], a[60:63], a[204:207], v[180:183]
    ds_read_b128 a[12:15], v207 offset:49152
    v_cvt_pk_bf16_f32 v185, v170, v171
    v_smfmac_f32_16x16x64_bf16 v[238:241], a[252:255], v[248:255], v202
    ds_read_b128 a[16:19], v204 offset:53248
    v_mfma_f32_16x16x32_bf16 v[104:107], v[248:251], a[72:75], v[104:107]
    v_exp_f32 v172, v172
    v_mfma_f32_16x16x32_bf16 v[104:107], v[252:255], a[104:107], v[104:107]
    ds_read_b128 a[20:23], v205 offset:53248
    v_mfma_f32_16x16x32_bf16 v[108:111], v[252:255], a[108:111], v[108:111]
    v_exp_f32 v173, v173
    v_mfma_f32_16x16x32_bf16 v[108:111], v[248:251], a[76:79], v[108:111]
    ds_read_b128 a[24:27], v206 offset:53248
    v_cvt_pk_bf16_f32 v186, v172, v173
    v_mfma_f32_16x16x32_bf16 v[112:115], v[248:251], a[80:83], v[112:115]
    v_exp_f32 v174, v174
    v_mfma_f32_16x16x32_bf16 v[112:115], v[252:255], a[112:115], v[112:115]
    ds_read_b128 a[28:31], v207 offset:53248
    v_mfma_f32_16x16x32_bf16 v[116:119], v[252:255], a[116:119], v[116:119]
    v_exp_f32 v175, v175
    v_mfma_f32_16x16x32_bf16 v[116:119], v[248:251], a[84:87], v[116:119]
    ds_read_b128 a[32:35], v204 offset:57344
    v_cvt_pk_bf16_f32 v187, v174, v175
    v_mfma_f32_16x16x32_bf16 v[120:123], v[248:251], a[88:91], v[120:123]
    v_exp_f32 v176, v176
    v_mfma_f32_16x16x32_bf16 v[120:123], v[252:255], a[120:123], v[120:123]
    ds_read_b128 a[36:39], v205 offset:57344
    v_mfma_f32_16x16x32_bf16 v[124:127], v[252:255], a[124:127], v[124:127]
    v_exp_f32 v177, v177
    v_mfma_f32_16x16x32_bf16 v[124:127], v[248:251], a[92:95], v[124:127]
    ds_read_b128 a[40:43], v206 offset:57344
    v_cvt_pk_bf16_f32 v188, v176, v177
    v_mfma_f32_16x16x32_bf16 v[96:99], v[248:251], a[64:67], v[96:99]
    v_exp_f32 v178, v178
    v_mfma_f32_16x16x32_bf16 v[96:99], v[252:255], a[96:99], v[96:99]
    ds_read_b128 a[44:47], v207 offset:57344
    v_mfma_f32_16x16x32_bf16 v[100:103], v[252:255], a[100:103], v[100:103]
    v_exp_f32 v179, v179
    v_mfma_f32_16x16x32_bf16 v[100:103], v[248:251], a[68:71], v[100:103]
    s_waitcnt lgkmcnt(3)
    ds_read_b128 a[48:51], v204 offset:61440
    v_cvt_pk_bf16_f32 v189, v178, v179
    v_mfma_f32_16x16x32_bf16 v[192:195], a[224:227], a[208:211], 0
    ds_read_b128 a[52:55], v205 offset:61440
    v_mfma_f32_16x16x32_bf16 v[192:195], a[228:231], a[212:215], v[192:195]
    ds_read_b128 a[56:59], v206 offset:61440
    v_mfma_f32_16x16x32_bf16 v[192:195], a[232:235], a[216:219], v[192:195]
    ds_read_b128 a[60:63], v207 offset:61440
    s_add_u32 m0, s22, 16384
    v_mfma_f32_16x16x32_bf16 v[192:195], a[236:239], a[220:223], v[192:195]
    buffer_load_dwordx4 v220, s[8:11], s21 offen nt lds
    v_mfma_f32_16x16x32_bf16 v[168:171], a[0:3], a[128:131], 0
    v_exp_f32 v180, v180
    v_mfma_f32_16x16x32_bf16 v[168:171], a[4:7], a[132:135], v[168:171]
    ds_read_b128 a[240:243], v227 offset:0
    v_mfma_f32_16x16x32_bf16 v[168:171], a[8:11], a[136:139], v[168:171]
    v_exp_f32 v181, v181
    v_mfma_f32_16x16x32_bf16 v[168:171], a[12:15], a[140:143], v[168:171]
    ds_read_b128 a[244:247], v227 offset:1024
    v_cvt_pk_bf16_f32 v190, v180, v181
    v_mfma_f32_16x16x32_bf16 v[172:175], a[16:19], a[128:131], 0
    v_exp_f32 v182, v182
    v_mfma_f32_16x16x32_bf16 v[172:175], a[20:23], a[132:135], v[172:175]
    v_exp_f32 v192, v192
    v_mfma_f32_16x16x32_bf16 v[172:175], a[24:27], a[136:139], v[172:175]
    v_exp_f32 v183, v183
    v_mfma_f32_16x16x32_bf16 v[172:175], a[28:31], a[140:143], v[172:175]
    v_cvt_pk_bf16_f32 v191, v182, v183
    v_mfma_f32_16x16x32_bf16 v[176:179], a[32:35], a[128:131], 0
    s_waitcnt lgkmcnt(1)
    v_exp_f32 v168, v168
    v_mfma_f32_16x16x32_bf16 v[176:179], a[36:39], a[132:135], v[176:179]
    v_exp_f32 v193, v193
    v_mfma_f32_16x16x32_bf16 v[176:179], a[40:43], a[136:139], v[176:179]
    v_exp_f32 v169, v169
    v_mfma_f32_16x16x32_bf16 v[176:179], a[44:47], a[140:143], v[176:179]
    v_cvt_pk_bf16_f32 v248, v168, v169
    v_cvt_pk_bf16_f32 v196, v192, v193
    v_mfma_f32_16x16x32_bf16 v[180:183], a[48:51], a[128:131], 0
    v_exp_f32 v170, v170
    v_mfma_f32_16x16x32_bf16 v[180:183], a[52:55], a[132:135], v[180:183]
    v_exp_f32 v194, v194
    v_mfma_f32_16x16x32_bf16 v[180:183], a[56:59], a[136:139], v[180:183]
    v_exp_f32 v171, v171
    v_mfma_f32_16x16x32_bf16 v[180:183], a[60:63], a[140:143], v[180:183]
    v_cvt_pk_bf16_f32 v249, v170, v171
    v_smfmac_f32_16x16x64_bf16 v[230:233], a[248:251], v[184:191], v202
    v_exp_f32 v195, v195
    v_mfma_f32_16x16x32_bf16 v[136:139], v[184:187], a[72:75], v[136:139]
    v_exp_f32 v172, v172
    v_mfma_f32_16x16x32_bf16 v[136:139], v[188:191], a[104:107], v[136:139]
    ds_read_b64_tr_b16 a[72:73], v210 offset:49152
    v_cvt_pk_bf16_f32 v197, v194, v195
    v_mfma_f32_16x16x32_bf16 v[140:143], v[188:191], a[108:111], v[140:143]
    v_exp_f32 v173, v173
    v_mfma_f32_16x16x32_bf16 v[140:143], v[184:187], a[76:79], v[140:143]
    ds_read_b64_tr_b16 a[74:75], v210 offset:53248
    v_cvt_pk_bf16_f32 v250, v172, v173
    v_mfma_f32_16x16x32_bf16 v[144:147], v[184:187], a[80:83], v[144:147]
    v_exp_f32 v174, v174
    v_mfma_f32_16x16x32_bf16 v[144:147], v[188:191], a[112:115], v[144:147]
    buffer_load_dwordx4 v221, s[8:11], s21 offen offset:1024 nt lds
    v_mfma_f32_16x16x32_bf16 v[148:151], v[188:191], a[116:119], v[148:151]
    v_exp_f32 v175, v175
    v_mfma_f32_16x16x32_bf16 v[148:151], v[184:187], a[84:87], v[148:151]
    ds_read_b64_tr_b16 a[104:105], v210 offset:57344
    v_cvt_pk_bf16_f32 v251, v174, v175
    v_mfma_f32_16x16x32_bf16 v[152:155], v[184:187], a[88:91], v[152:155]
    v_exp_f32 v176, v176
    v_mfma_f32_16x16x32_bf16 v[152:155], v[188:191], a[120:123], v[152:155]
    ds_read_b64_tr_b16 a[106:107], v210 offset:61440
    ds_read_b64_tr_b16 a[108:109], v211 offset:57344
    v_mfma_f32_16x16x32_bf16 v[156:159], v[188:191], a[124:127], v[156:159]
    v_exp_f32 v177, v177
    v_mfma_f32_16x16x32_bf16 v[156:159], v[184:187], a[92:95], v[156:159]
    ds_read_b64_tr_b16 a[110:111], v211 offset:61440
    v_cvt_pk_bf16_f32 v252, v176, v177
    v_mfma_f32_16x16x32_bf16 v[128:131], v[184:187], a[64:67], v[128:131]
    v_exp_f32 v178, v178
    v_mfma_f32_16x16x32_bf16 v[128:131], v[188:191], a[96:99], v[128:131]
    ds_read_b64_tr_b16 a[76:77], v211 offset:49152
    ds_read_b64_tr_b16 a[78:79], v211 offset:53248
    v_mfma_f32_16x16x32_bf16 v[132:135], v[188:191], a[100:103], v[132:135]
    v_exp_f32 v179, v179
    v_mfma_f32_16x16x32_bf16 v[132:135], v[184:187], a[68:71], v[132:135]
    s_waitcnt lgkmcnt(4)
    ds_read_b64_tr_b16 a[80:81], v212 offset:49152
    v_cvt_pk_bf16_f32 v253, v178, v179
    v_smfmac_f32_16x16x64_bf16 v[230:233], a[252:255], a[240:247], v202
    ds_write_b64 v226, v[196:197] offset:2048
    v_mfma_f32_16x16x32_bf16 v[160:163], a[240:243], a[64:67], v[160:163]
    ds_read_b64_tr_b16 a[82:83], v212 offset:53248
    ds_read_b64_tr_b16 a[112:113], v212 offset:57344
    v_mfma_f32_16x16x32_bf16 v[160:163], a[244:247], a[96:99], v[160:163]
    ds_read_b64_tr_b16 a[114:115], v212 offset:61440
    ds_read_b64_tr_b16 a[116:117], v213 offset:57344
    v_mfma_f32_16x16x32_bf16 v[164:167], a[244:247], a[100:103], v[164:167]
    ds_read_b64_tr_b16 a[118:119], v213 offset:61440
    ds_read_b64_tr_b16 a[84:85], v213 offset:49152
    v_mfma_f32_16x16x32_bf16 v[164:167], a[240:243], a[68:71], v[164:167]
    ds_read_b64_tr_b16 a[86:87], v213 offset:53248
    ds_read_b64_tr_b16 a[88:89], v214 offset:49152
    v_mfma_f32_16x16x32_bf16 v[168:171], a[0:3], a[144:147], 0
    v_exp_f32 v180, v180
    v_mfma_f32_16x16x32_bf16 v[168:171], a[4:7], a[148:151], v[168:171]
    buffer_load_dwordx4 v222, s[8:11], s21 offen offset:2048 nt lds
    v_mfma_f32_16x16x32_bf16 v[168:171], a[8:11], a[152:155], v[168:171]
    v_exp_f32 v181, v181
    v_mfma_f32_16x16x32_bf16 v[168:171], a[12:15], a[156:159], v[168:171]
    ds_read_b64_tr_b16 a[90:91], v214 offset:53248
    v_cvt_pk_bf16_f32 v254, v180, v181
    v_mfma_f32_16x16x32_bf16 v[172:175], a[16:19], a[144:147], 0
    v_exp_f32 v182, v182
    v_mfma_f32_16x16x32_bf16 v[172:175], a[20:23], a[148:151], v[172:175]
    ds_read_b64_tr_b16 a[120:121], v214 offset:57344
    ds_read_b64_tr_b16 a[122:123], v214 offset:61440
    v_mfma_f32_16x16x32_bf16 v[172:175], a[24:27], a[152:155], v[172:175]
    v_exp_f32 v183, v183
    v_mfma_f32_16x16x32_bf16 v[172:175], a[28:31], a[156:159], v[172:175]
    ds_read_b64_tr_b16 a[124:125], v215 offset:57344
    v_cvt_pk_bf16_f32 v255, v182, v183
    v_mfma_f32_16x16x32_bf16 v[176:179], a[32:35], a[144:147], 0
    v_exp_f32 v168, v168
    v_mfma_f32_16x16x32_bf16 v[176:179], a[36:39], a[148:151], v[176:179]
    ds_read_b64_tr_b16 a[126:127], v215 offset:61440
    ds_read_b64_tr_b16 a[92:93], v215 offset:49152
    v_mfma_f32_16x16x32_bf16 v[176:179], a[40:43], a[152:155], v[176:179]
    v_exp_f32 v169, v169
    v_mfma_f32_16x16x32_bf16 v[176:179], a[44:47], a[156:159], v[176:179]
    ds_read_b64_tr_b16 a[94:95], v215 offset:53248
    v_cvt_pk_bf16_f32 v184, v168, v169
    v_mfma_f32_16x16x32_bf16 v[180:183], a[48:51], a[144:147], 0
    v_exp_f32 v170, v170
    v_mfma_f32_16x16x32_bf16 v[180:183], a[52:55], a[148:151], v[180:183]
    ds_read_b64_tr_b16 a[64:65], v208 offset:49152
    ds_read_b64_tr_b16 a[66:67], v208 offset:53248
    v_mfma_f32_16x16x32_bf16 v[180:183], a[56:59], a[152:155], v[180:183]
    v_exp_f32 v171, v171
    v_mfma_f32_16x16x32_bf16 v[180:183], a[60:63], a[156:159], v[180:183]
    ds_read_b64_tr_b16 a[96:97], v208 offset:57344
    v_cvt_pk_bf16_f32 v185, v170, v171
    v_smfmac_f32_16x16x64_bf16 v[234:237], a[248:251], v[248:255], v202
    ds_read_b64_tr_b16 a[98:99], v208 offset:61440
    ds_read_b64_tr_b16 a[100:101], v209 offset:57344
    v_mfma_f32_16x16x32_bf16 v[8:11], v[248:251], a[72:75], v[8:11]
    v_exp_f32 v172, v172
    v_mfma_f32_16x16x32_bf16 v[8:11], v[252:255], a[104:107], v[8:11]
    s_waitcnt lgkmcnt(5)
    ds_read_b64_tr_b16 a[102:103], v209 offset:61440
    ds_read_b64_tr_b16 a[68:69], v209 offset:49152
    v_mfma_f32_16x16x32_bf16 v[12:15], v[252:255], a[108:111], v[12:15]
    v_exp_f32 v173, v173
    v_mfma_f32_16x16x32_bf16 v[12:15], v[248:251], a[76:79], v[12:15]
    ds_read_b64_tr_b16 a[70:71], v209 offset:53248
    v_cvt_pk_bf16_f32 v186, v172, v173
    v_mfma_f32_16x16x32_bf16 v[16:19], v[248:251], a[80:83], v[16:19]
    v_exp_f32 v174, v174
    v_mfma_f32_16x16x32_bf16 v[16:19], v[252:255], a[112:115], v[16:19]
    buffer_load_dwordx4 v223, s[8:11], s21 offen offset:3072 nt lds
    v_mfma_f32_16x16x32_bf16 v[20:23], v[252:255], a[116:119], v[20:23]
    v_exp_f32 v175, v175
    v_mfma_f32_16x16x32_bf16 v[20:23], v[248:251], a[84:87], v[20:23]
    v_cvt_pk_bf16_f32 v187, v174, v175
    v_mfma_f32_16x16x32_bf16 v[24:27], v[248:251], a[88:91], v[24:27]
    v_exp_f32 v176, v176
    s_add_u32 m0, s22, 81920
    v_mfma_f32_16x16x32_bf16 v[24:27], v[252:255], a[120:123], v[24:27]
    buffer_load_dwordx4 v224, s[12:15], s21 offen nt lds
    v_mfma_f32_16x16x32_bf16 v[28:31], v[252:255], a[124:127], v[28:31]
    v_exp_f32 v177, v177
    v_mfma_f32_16x16x32_bf16 v[28:31], v[248:251], a[92:95], v[28:31]
    s_waitcnt lgkmcnt(0)
    v_cvt_pk_bf16_f32 v188, v176, v177
    v_mfma_f32_16x16x32_bf16 v[0:3], v[248:251], a[64:67], v[0:3]
    v_exp_f32 v178, v178
    v_mfma_f32_16x16x32_bf16 v[0:3], v[252:255], a[96:99], v[0:3]
    v_mfma_f32_16x16x32_bf16 v[4:7], v[252:255], a[100:103], v[4:7]
    v_exp_f32 v179, v179
    v_mfma_f32_16x16x32_bf16 v[4:7], v[248:251], a[68:71], v[4:7]
    v_cvt_pk_bf16_f32 v189, v178, v179
    v_mfma_f32_16x16x32_bf16 v[168:171], a[0:3], a[160:163], 0
    v_exp_f32 v180, v180
    v_mfma_f32_16x16x32_bf16 v[168:171], a[4:7], a[164:167], v[168:171]
    v_mfma_f32_16x16x32_bf16 v[168:171], a[8:11], a[168:171], v[168:171]
    v_exp_f32 v181, v181
    v_mfma_f32_16x16x32_bf16 v[168:171], a[12:15], a[172:175], v[168:171]
    v_cvt_pk_bf16_f32 v190, v180, v181
    v_mfma_f32_16x16x32_bf16 v[172:175], a[16:19], a[160:163], 0
    v_exp_f32 v182, v182
    v_mfma_f32_16x16x32_bf16 v[172:175], a[20:23], a[164:167], v[172:175]
    v_mfma_f32_16x16x32_bf16 v[172:175], a[24:27], a[168:171], v[172:175]
    v_exp_f32 v183, v183
    v_mfma_f32_16x16x32_bf16 v[172:175], a[28:31], a[172:175], v[172:175]
    v_cvt_pk_bf16_f32 v191, v182, v183
    v_mfma_f32_16x16x32_bf16 v[176:179], a[32:35], a[160:163], 0
    v_exp_f32 v168, v168
    v_mfma_f32_16x16x32_bf16 v[176:179], a[36:39], a[164:167], v[176:179]
    buffer_load_dwordx4 v225, s[12:15], s21 offen offset:1024 nt lds
    v_mfma_f32_16x16x32_bf16 v[176:179], a[40:43], a[168:171], v[176:179]
    v_exp_f32 v169, v169
    v_mfma_f32_16x16x32_bf16 v[176:179], a[44:47], a[172:175], v[176:179]
    v_cvt_pk_bf16_f32 v248, v168, v169
    v_mfma_f32_16x16x32_bf16 v[180:183], a[48:51], a[160:163], 0
    v_exp_f32 v170, v170
    v_mfma_f32_16x16x32_bf16 v[180:183], a[52:55], a[164:167], v[180:183]
    v_mfma_f32_16x16x32_bf16 v[180:183], a[56:59], a[168:171], v[180:183]
    v_exp_f32 v171, v171
    v_mfma_f32_16x16x32_bf16 v[180:183], a[60:63], a[172:175], v[180:183]
    v_cvt_pk_bf16_f32 v249, v170, v171
    v_smfmac_f32_16x16x64_bf16 v[234:237], a[252:255], v[184:191], v202
    v_mfma_f32_16x16x32_bf16 v[40:43], v[184:187], a[72:75], v[40:43]
    v_exp_f32 v172, v172
    v_mfma_f32_16x16x32_bf16 v[40:43], v[188:191], a[104:107], v[40:43]
    v_mfma_f32_16x16x32_bf16 v[44:47], v[188:191], a[108:111], v[44:47]
    v_exp_f32 v173, v173
    v_mfma_f32_16x16x32_bf16 v[44:47], v[184:187], a[76:79], v[44:47]
    v_cvt_pk_bf16_f32 v250, v172, v173
    v_mfma_f32_16x16x32_bf16 v[48:51], v[184:187], a[80:83], v[48:51]
    v_exp_f32 v174, v174
    v_mfma_f32_16x16x32_bf16 v[48:51], v[188:191], a[112:115], v[48:51]
    v_mfma_f32_16x16x32_bf16 v[52:55], v[188:191], a[116:119], v[52:55]
    v_exp_f32 v175, v175
    v_mfma_f32_16x16x32_bf16 v[52:55], v[184:187], a[84:87], v[52:55]
    v_cvt_pk_bf16_f32 v251, v174, v175
    v_mfma_f32_16x16x32_bf16 v[56:59], v[184:187], a[88:91], v[56:59]
    v_exp_f32 v176, v176
    v_mfma_f32_16x16x32_bf16 v[56:59], v[188:191], a[120:123], v[56:59]
    buffer_load_dwordx4 v224, s[12:15], s21 offen offset:2048 nt lds
    v_mfma_f32_16x16x32_bf16 v[60:63], v[188:191], a[124:127], v[60:63]
    v_exp_f32 v177, v177
    v_mfma_f32_16x16x32_bf16 v[60:63], v[184:187], a[92:95], v[60:63]
    v_cvt_pk_bf16_f32 v252, v176, v177
    v_mfma_f32_16x16x32_bf16 v[32:35], v[184:187], a[64:67], v[32:35]
    v_exp_f32 v178, v178
    v_mfma_f32_16x16x32_bf16 v[32:35], v[188:191], a[96:99], v[32:35]
    v_mfma_f32_16x16x32_bf16 v[36:39], v[188:191], a[100:103], v[36:39]
    v_exp_f32 v179, v179
    v_mfma_f32_16x16x32_bf16 v[36:39], v[184:187], a[68:71], v[36:39]
    v_cvt_pk_bf16_f32 v253, v178, v179
    v_mfma_f32_16x16x32_bf16 v[168:171], a[0:3], a[176:179], 0
    v_exp_f32 v180, v180
    v_mfma_f32_16x16x32_bf16 v[168:171], a[4:7], a[180:183], v[168:171]
    v_mfma_f32_16x16x32_bf16 v[168:171], a[8:11], a[184:187], v[168:171]
    v_exp_f32 v181, v181
    v_mfma_f32_16x16x32_bf16 v[168:171], a[12:15], a[188:191], v[168:171]
    v_cvt_pk_bf16_f32 v254, v180, v181
    v_mfma_f32_16x16x32_bf16 v[172:175], a[16:19], a[176:179], 0
    v_exp_f32 v182, v182
    v_mfma_f32_16x16x32_bf16 v[172:175], a[20:23], a[180:183], v[172:175]
    v_mfma_f32_16x16x32_bf16 v[172:175], a[24:27], a[184:187], v[172:175]
    v_exp_f32 v183, v183
    v_mfma_f32_16x16x32_bf16 v[172:175], a[28:31], a[188:191], v[172:175]
    v_cvt_pk_bf16_f32 v255, v182, v183
    v_mfma_f32_16x16x32_bf16 v[176:179], a[32:35], a[176:179], 0
    v_exp_f32 v168, v168
    v_mfma_f32_16x16x32_bf16 v[176:179], a[36:39], a[180:183], v[176:179]
    buffer_load_dwordx4 v225, s[12:15], s21 offen offset:3072 nt lds
    v_mfma_f32_16x16x32_bf16 v[176:179], a[40:43], a[184:187], v[176:179]
    v_exp_f32 v169, v169
    v_mfma_f32_16x16x32_bf16 v[176:179], a[44:47], a[188:191], v[176:179]
    v_cvt_pk_bf16_f32 v184, v168, v169
    v_mfma_f32_16x16x32_bf16 v[180:183], a[48:51], a[176:179], 0
    v_exp_f32 v170, v170
    v_mfma_f32_16x16x32_bf16 v[180:183], a[52:55], a[180:183], v[180:183]
    v_mfma_f32_16x16x32_bf16 v[180:183], a[56:59], a[184:187], v[180:183]
    v_exp_f32 v171, v171
    v_mfma_f32_16x16x32_bf16 v[180:183], a[60:63], a[188:191], v[180:183]
    v_cvt_pk_bf16_f32 v185, v170, v171
    v_smfmac_f32_16x16x64_bf16 v[238:241], a[248:251], v[248:255], v202
    v_mfma_f32_16x16x32_bf16 v[72:75], v[248:251], a[72:75], v[72:75]
    v_exp_f32 v172, v172
    v_mfma_f32_16x16x32_bf16 v[72:75], v[252:255], a[104:107], v[72:75]
    v_mfma_f32_16x16x32_bf16 v[76:79], v[252:255], a[108:111], v[76:79]
    v_exp_f32 v173, v173
    v_mfma_f32_16x16x32_bf16 v[76:79], v[248:251], a[76:79], v[76:79]
    v_cvt_pk_bf16_f32 v186, v172, v173
    v_mfma_f32_16x16x32_bf16 v[80:83], v[248:251], a[80:83], v[80:83]
    v_exp_f32 v174, v174
    v_mfma_f32_16x16x32_bf16 v[80:83], v[252:255], a[112:115], v[80:83]
    v_mfma_f32_16x16x32_bf16 v[84:87], v[252:255], a[116:119], v[84:87]
    v_exp_f32 v175, v175
    v_mfma_f32_16x16x32_bf16 v[84:87], v[248:251], a[84:87], v[84:87]
    v_cvt_pk_bf16_f32 v187, v174, v175
    v_mfma_f32_16x16x32_bf16 v[88:91], v[248:251], a[88:91], v[88:91]
    v_exp_f32 v176, v176
    v_mfma_f32_16x16x32_bf16 v[88:91], v[252:255], a[120:123], v[88:91]
    v_mfma_f32_16x16x32_bf16 v[92:95], v[252:255], a[124:127], v[92:95]
    v_exp_f32 v177, v177
    v_mfma_f32_16x16x32_bf16 v[92:95], v[248:251], a[92:95], v[92:95]
    v_cvt_pk_bf16_f32 v188, v176, v177
    v_mfma_f32_16x16x32_bf16 v[64:67], v[248:251], a[64:67], v[64:67]
    v_exp_f32 v178, v178
    v_mfma_f32_16x16x32_bf16 v[64:67], v[252:255], a[96:99], v[64:67]
    v_mfma_f32_16x16x32_bf16 v[68:71], v[252:255], a[100:103], v[68:71]
    v_exp_f32 v179, v179
    v_mfma_f32_16x16x32_bf16 v[68:71], v[248:251], a[68:71], v[68:71]
    v_cvt_pk_bf16_f32 v189, v178, v179
    s_add_u32 s21, s21, 16384
    s_waitcnt vmcnt(8) lgkmcnt(15)
    s_barrier
    v_mfma_f32_16x16x32_bf16 v[168:171], a[0:3], a[192:195], 0
    v_exp_f32 v180, v180
    v_mfma_f32_16x16x32_bf16 v[168:171], a[4:7], a[196:199], v[168:171]
    ds_read_b128 a[224:227], v216 offset:0
    v_mfma_f32_16x16x32_bf16 v[168:171], a[8:11], a[200:203], v[168:171]
    v_exp_f32 v181, v181
    v_mfma_f32_16x16x32_bf16 v[168:171], a[12:15], a[204:207], v[168:171]
    ds_read_b128 a[228:231], v217 offset:0
    v_cvt_pk_bf16_f32 v190, v180, v181
    v_mfma_f32_16x16x32_bf16 v[172:175], a[16:19], a[192:195], 0
    v_exp_f32 v182, v182
    v_mfma_f32_16x16x32_bf16 v[172:175], a[20:23], a[196:199], v[172:175]
    ds_read_b128 a[232:235], v218 offset:0
    v_mfma_f32_16x16x32_bf16 v[172:175], a[24:27], a[200:203], v[172:175]
    v_exp_f32 v183, v183
    v_mfma_f32_16x16x32_bf16 v[172:175], a[28:31], a[204:207], v[172:175]
    ds_read_b128 a[236:239], v219 offset:0
    v_cvt_pk_bf16_f32 v191, v182, v183
    v_mfma_f32_16x16x32_bf16 v[176:179], a[32:35], a[192:195], 0
    v_exp_f32 v168, v168
    v_mfma_f32_16x16x32_bf16 v[176:179], a[36:39], a[196:199], v[176:179]
    ds_read_b128 a[0:3], v204 offset:0
    v_mfma_f32_16x16x32_bf16 v[176:179], a[40:43], a[200:203], v[176:179]
    v_exp_f32 v169, v169
    v_mfma_f32_16x16x32_bf16 v[176:179], a[44:47], a[204:207], v[176:179]
    ds_read_b128 a[4:7], v205 offset:0
    v_cvt_pk_bf16_f32 v248, v168, v169
    v_mfma_f32_16x16x32_bf16 v[180:183], a[48:51], a[192:195], 0
    v_exp_f32 v170, v170
    v_mfma_f32_16x16x32_bf16 v[180:183], a[52:55], a[196:199], v[180:183]
    ds_read_b128 a[8:11], v206 offset:0
    v_mfma_f32_16x16x32_bf16 v[180:183], a[56:59], a[200:203], v[180:183]
    v_exp_f32 v171, v171
    v_mfma_f32_16x16x32_bf16 v[180:183], a[60:63], a[204:207], v[180:183]
    ds_read_b128 a[12:15], v207 offset:0
    v_cvt_pk_bf16_f32 v249, v170, v171
    v_smfmac_f32_16x16x64_bf16 v[238:241], a[252:255], v[184:191], v202
    ds_read_b128 a[16:19], v204 offset:4096
    v_mfma_f32_16x16x32_bf16 v[104:107], v[184:187], a[72:75], v[104:107]
    v_exp_f32 v172, v172
    v_mfma_f32_16x16x32_bf16 v[104:107], v[188:191], a[104:107], v[104:107]
    ds_read_b128 a[20:23], v205 offset:4096
    v_mfma_f32_16x16x32_bf16 v[108:111], v[188:191], a[108:111], v[108:111]
    v_exp_f32 v173, v173
    v_mfma_f32_16x16x32_bf16 v[108:111], v[184:187], a[76:79], v[108:111]
    ds_read_b128 a[24:27], v206 offset:4096
    v_cvt_pk_bf16_f32 v250, v172, v173
    v_mfma_f32_16x16x32_bf16 v[112:115], v[184:187], a[80:83], v[112:115]
    v_exp_f32 v174, v174
    v_mfma_f32_16x16x32_bf16 v[112:115], v[188:191], a[112:115], v[112:115]
    ds_read_b128 a[28:31], v207 offset:4096
    v_mfma_f32_16x16x32_bf16 v[116:119], v[188:191], a[116:119], v[116:119]
    v_exp_f32 v175, v175
    v_mfma_f32_16x16x32_bf16 v[116:119], v[184:187], a[84:87], v[116:119]
    ds_read_b128 a[32:35], v204 offset:8192
    v_cvt_pk_bf16_f32 v251, v174, v175
    v_mfma_f32_16x16x32_bf16 v[120:123], v[184:187], a[88:91], v[120:123]
    v_exp_f32 v176, v176
    v_mfma_f32_16x16x32_bf16 v[120:123], v[188:191], a[120:123], v[120:123]
    ds_read_b128 a[36:39], v205 offset:8192
    v_mfma_f32_16x16x32_bf16 v[124:127], v[188:191], a[124:127], v[124:127]
    v_exp_f32 v177, v177
    v_mfma_f32_16x16x32_bf16 v[124:127], v[184:187], a[92:95], v[124:127]
    ds_read_b128 a[40:43], v206 offset:8192
    v_cvt_pk_bf16_f32 v252, v176, v177
    v_mfma_f32_16x16x32_bf16 v[96:99], v[184:187], a[64:67], v[96:99]
    v_exp_f32 v178, v178
    v_mfma_f32_16x16x32_bf16 v[96:99], v[188:191], a[96:99], v[96:99]
    ds_read_b128 a[44:47], v207 offset:8192
    v_mfma_f32_16x16x32_bf16 v[100:103], v[188:191], a[100:103], v[100:103]
    v_exp_f32 v179, v179
    v_mfma_f32_16x16x32_bf16 v[100:103], v[184:187], a[68:71], v[100:103]
    s_waitcnt lgkmcnt(3)
    ds_read_b128 a[48:51], v204 offset:12288
    v_cvt_pk_bf16_f32 v253, v178, v179
    v_mfma_f32_16x16x32_bf16 v[192:195], a[224:227], a[208:211], 0
    ds_read_b128 a[52:55], v205 offset:12288
    v_mfma_f32_16x16x32_bf16 v[192:195], a[228:231], a[212:215], v[192:195]
    ds_read_b128 a[56:59], v206 offset:12288
    v_mfma_f32_16x16x32_bf16 v[192:195], a[232:235], a[216:219], v[192:195]
    ds_read_b128 a[60:63], v207 offset:12288
    s_add_u32 m0, s22, 32768
    v_mfma_f32_16x16x32_bf16 v[192:195], a[236:239], a[220:223], v[192:195]
    buffer_load_dwordx4 v220, s[8:11], s21 offen nt lds
    v_mfma_f32_16x16x32_bf16 v[168:171], a[0:3], a[128:131], 0
    v_exp_f32 v180, v180
    v_mfma_f32_16x16x32_bf16 v[168:171], a[4:7], a[132:135], v[168:171]
    ds_read_b128 a[240:243], v227 offset:2048
    v_mfma_f32_16x16x32_bf16 v[168:171], a[8:11], a[136:139], v[168:171]
    v_exp_f32 v181, v181
    v_mfma_f32_16x16x32_bf16 v[168:171], a[12:15], a[140:143], v[168:171]
    ds_read_b128 a[244:247], v227 offset:3072
    v_cvt_pk_bf16_f32 v254, v180, v181
    v_mfma_f32_16x16x32_bf16 v[172:175], a[16:19], a[128:131], 0
    v_exp_f32 v182, v182
    v_mfma_f32_16x16x32_bf16 v[172:175], a[20:23], a[132:135], v[172:175]
    v_exp_f32 v192, v192
    v_mfma_f32_16x16x32_bf16 v[172:175], a[24:27], a[136:139], v[172:175]
    v_exp_f32 v183, v183
    v_mfma_f32_16x16x32_bf16 v[172:175], a[28:31], a[140:143], v[172:175]
    v_cvt_pk_bf16_f32 v255, v182, v183
    v_mfma_f32_16x16x32_bf16 v[176:179], a[32:35], a[128:131], 0
    s_waitcnt lgkmcnt(1)
    v_exp_f32 v168, v168
    v_mfma_f32_16x16x32_bf16 v[176:179], a[36:39], a[132:135], v[176:179]
    v_exp_f32 v193, v193
    v_mfma_f32_16x16x32_bf16 v[176:179], a[40:43], a[136:139], v[176:179]
    v_exp_f32 v169, v169
    v_mfma_f32_16x16x32_bf16 v[176:179], a[44:47], a[140:143], v[176:179]
    v_cvt_pk_bf16_f32 v184, v168, v169
    v_cvt_pk_bf16_f32 v196, v192, v193
    v_mfma_f32_16x16x32_bf16 v[180:183], a[48:51], a[128:131], 0
    v_exp_f32 v170, v170
    v_mfma_f32_16x16x32_bf16 v[180:183], a[52:55], a[132:135], v[180:183]
    v_exp_f32 v194, v194
    v_mfma_f32_16x16x32_bf16 v[180:183], a[56:59], a[136:139], v[180:183]
    v_exp_f32 v171, v171
    v_mfma_f32_16x16x32_bf16 v[180:183], a[60:63], a[140:143], v[180:183]
    v_cvt_pk_bf16_f32 v185, v170, v171
    v_smfmac_f32_16x16x64_bf16 v[230:233], a[248:251], v[248:255], v202
    v_exp_f32 v195, v195
    v_mfma_f32_16x16x32_bf16 v[136:139], v[248:251], a[72:75], v[136:139]
    v_exp_f32 v172, v172
    v_mfma_f32_16x16x32_bf16 v[136:139], v[252:255], a[104:107], v[136:139]
    ds_read_b64_tr_b16 a[72:73], v210 offset:0
    v_cvt_pk_bf16_f32 v197, v194, v195
    v_mfma_f32_16x16x32_bf16 v[140:143], v[252:255], a[108:111], v[140:143]
    v_exp_f32 v173, v173
    v_mfma_f32_16x16x32_bf16 v[140:143], v[248:251], a[76:79], v[140:143]
    ds_read_b64_tr_b16 a[74:75], v210 offset:4096
    v_cvt_pk_bf16_f32 v186, v172, v173
    v_mfma_f32_16x16x32_bf16 v[144:147], v[248:251], a[80:83], v[144:147]
    v_exp_f32 v174, v174
    v_mfma_f32_16x16x32_bf16 v[144:147], v[252:255], a[112:115], v[144:147]
    buffer_load_dwordx4 v221, s[8:11], s21 offen offset:1024 nt lds
    v_mfma_f32_16x16x32_bf16 v[148:151], v[252:255], a[116:119], v[148:151]
    v_exp_f32 v175, v175
    v_mfma_f32_16x16x32_bf16 v[148:151], v[248:251], a[84:87], v[148:151]
    ds_read_b64_tr_b16 a[104:105], v210 offset:8192
    v_cvt_pk_bf16_f32 v187, v174, v175
    v_mfma_f32_16x16x32_bf16 v[152:155], v[248:251], a[88:91], v[152:155]
    v_exp_f32 v176, v176
    v_mfma_f32_16x16x32_bf16 v[152:155], v[252:255], a[120:123], v[152:155]
    ds_read_b64_tr_b16 a[106:107], v210 offset:12288
    ds_read_b64_tr_b16 a[108:109], v211 offset:8192
    v_mfma_f32_16x16x32_bf16 v[156:159], v[252:255], a[124:127], v[156:159]
    v_exp_f32 v177, v177
    v_mfma_f32_16x16x32_bf16 v[156:159], v[248:251], a[92:95], v[156:159]
    ds_read_b64_tr_b16 a[110:111], v211 offset:12288
    v_cvt_pk_bf16_f32 v188, v176, v177
    v_mfma_f32_16x16x32_bf16 v[128:131], v[248:251], a[64:67], v[128:131]
    v_exp_f32 v178, v178
    v_mfma_f32_16x16x32_bf16 v[128:131], v[252:255], a[96:99], v[128:131]
    ds_read_b64_tr_b16 a[76:77], v211 offset:0
    ds_read_b64_tr_b16 a[78:79], v211 offset:4096
    v_mfma_f32_16x16x32_bf16 v[132:135], v[252:255], a[100:103], v[132:135]
    v_exp_f32 v179, v179
    v_mfma_f32_16x16x32_bf16 v[132:135], v[248:251], a[68:71], v[132:135]
    s_waitcnt lgkmcnt(4)
    ds_read_b64_tr_b16 a[80:81], v212 offset:0
    v_cvt_pk_bf16_f32 v189, v178, v179
    v_smfmac_f32_16x16x64_bf16 v[230:233], a[252:255], a[240:247], v202
    ds_write_b64 v226, v[196:197] offset:0
    v_mfma_f32_16x16x32_bf16 v[160:163], a[240:243], a[64:67], v[160:163]
    ds_read_b64_tr_b16 a[82:83], v212 offset:4096
    ds_read_b64_tr_b16 a[112:113], v212 offset:8192
    v_mfma_f32_16x16x32_bf16 v[160:163], a[244:247], a[96:99], v[160:163]
    ds_read_b64_tr_b16 a[114:115], v212 offset:12288
    ds_read_b64_tr_b16 a[116:117], v213 offset:8192
    v_mfma_f32_16x16x32_bf16 v[164:167], a[244:247], a[100:103], v[164:167]
    ds_read_b64_tr_b16 a[118:119], v213 offset:12288
    ds_read_b64_tr_b16 a[84:85], v213 offset:0
    v_mfma_f32_16x16x32_bf16 v[164:167], a[240:243], a[68:71], v[164:167]
    ds_read_b64_tr_b16 a[86:87], v213 offset:4096
    ds_read_b64_tr_b16 a[88:89], v214 offset:0
    v_mfma_f32_16x16x32_bf16 v[168:171], a[0:3], a[144:147], 0
    v_exp_f32 v180, v180
    v_mfma_f32_16x16x32_bf16 v[168:171], a[4:7], a[148:151], v[168:171]
    buffer_load_dwordx4 v222, s[8:11], s21 offen offset:2048 nt lds
    v_mfma_f32_16x16x32_bf16 v[168:171], a[8:11], a[152:155], v[168:171]
    v_exp_f32 v181, v181
    v_mfma_f32_16x16x32_bf16 v[168:171], a[12:15], a[156:159], v[168:171]
    ds_read_b64_tr_b16 a[90:91], v214 offset:4096
    v_cvt_pk_bf16_f32 v190, v180, v181
    v_mfma_f32_16x16x32_bf16 v[172:175], a[16:19], a[144:147], 0
    v_exp_f32 v182, v182
    v_mfma_f32_16x16x32_bf16 v[172:175], a[20:23], a[148:151], v[172:175]
    ds_read_b64_tr_b16 a[120:121], v214 offset:8192
    ds_read_b64_tr_b16 a[122:123], v214 offset:12288
    v_mfma_f32_16x16x32_bf16 v[172:175], a[24:27], a[152:155], v[172:175]
    v_exp_f32 v183, v183
    v_mfma_f32_16x16x32_bf16 v[172:175], a[28:31], a[156:159], v[172:175]
    ds_read_b64_tr_b16 a[124:125], v215 offset:8192
    v_cvt_pk_bf16_f32 v191, v182, v183
    v_mfma_f32_16x16x32_bf16 v[176:179], a[32:35], a[144:147], 0
    v_exp_f32 v168, v168
    v_mfma_f32_16x16x32_bf16 v[176:179], a[36:39], a[148:151], v[176:179]
    ds_read_b64_tr_b16 a[126:127], v215 offset:12288
    ds_read_b64_tr_b16 a[92:93], v215 offset:0
    v_mfma_f32_16x16x32_bf16 v[176:179], a[40:43], a[152:155], v[176:179]
    v_exp_f32 v169, v169
    v_mfma_f32_16x16x32_bf16 v[176:179], a[44:47], a[156:159], v[176:179]
    ds_read_b64_tr_b16 a[94:95], v215 offset:4096
    v_cvt_pk_bf16_f32 v248, v168, v169
    v_mfma_f32_16x16x32_bf16 v[180:183], a[48:51], a[144:147], 0
    v_exp_f32 v170, v170
    v_mfma_f32_16x16x32_bf16 v[180:183], a[52:55], a[148:151], v[180:183]
    ds_read_b64_tr_b16 a[64:65], v208 offset:0
    ds_read_b64_tr_b16 a[66:67], v208 offset:4096
    v_mfma_f32_16x16x32_bf16 v[180:183], a[56:59], a[152:155], v[180:183]
    v_exp_f32 v171, v171
    v_mfma_f32_16x16x32_bf16 v[180:183], a[60:63], a[156:159], v[180:183]
    ds_read_b64_tr_b16 a[96:97], v208 offset:8192
    v_cvt_pk_bf16_f32 v249, v170, v171
    v_smfmac_f32_16x16x64_bf16 v[234:237], a[248:251], v[184:191], v202
    ds_read_b64_tr_b16 a[98:99], v208 offset:12288
    ds_read_b64_tr_b16 a[100:101], v209 offset:8192
    v_mfma_f32_16x16x32_bf16 v[8:11], v[184:187], a[72:75], v[8:11]
    v_exp_f32 v172, v172
    v_mfma_f32_16x16x32_bf16 v[8:11], v[188:191], a[104:107], v[8:11]
    s_waitcnt lgkmcnt(5)
    ds_read_b64_tr_b16 a[102:103], v209 offset:12288
    ds_read_b64_tr_b16 a[68:69], v209 offset:0
    v_mfma_f32_16x16x32_bf16 v[12:15], v[188:191], a[108:111], v[12:15]
    v_exp_f32 v173, v173
    v_mfma_f32_16x16x32_bf16 v[12:15], v[184:187], a[76:79], v[12:15]
    ds_read_b64_tr_b16 a[70:71], v209 offset:4096
    v_cvt_pk_bf16_f32 v250, v172, v173
    v_mfma_f32_16x16x32_bf16 v[16:19], v[184:187], a[80:83], v[16:19]
    v_exp_f32 v174, v174
    v_mfma_f32_16x16x32_bf16 v[16:19], v[188:191], a[112:115], v[16:19]
    buffer_load_dwordx4 v223, s[8:11], s21 offen offset:3072 nt lds
    v_mfma_f32_16x16x32_bf16 v[20:23], v[188:191], a[116:119], v[20:23]
    v_exp_f32 v175, v175
    v_mfma_f32_16x16x32_bf16 v[20:23], v[184:187], a[84:87], v[20:23]
    v_cvt_pk_bf16_f32 v251, v174, v175
    v_mfma_f32_16x16x32_bf16 v[24:27], v[184:187], a[88:91], v[24:27]
    v_exp_f32 v176, v176
    s_add_u32 m0, s22, 98304
    v_mfma_f32_16x16x32_bf16 v[24:27], v[188:191], a[120:123], v[24:27]
    buffer_load_dwordx4 v224, s[12:15], s21 offen nt lds
    v_mfma_f32_16x16x32_bf16 v[28:31], v[188:191], a[124:127], v[28:31]
    v_exp_f32 v177, v177
    v_mfma_f32_16x16x32_bf16 v[28:31], v[184:187], a[92:95], v[28:31]
    s_waitcnt lgkmcnt(0)
    v_cvt_pk_bf16_f32 v252, v176, v177
    v_mfma_f32_16x16x32_bf16 v[0:3], v[184:187], a[64:67], v[0:3]
    v_exp_f32 v178, v178
    v_mfma_f32_16x16x32_bf16 v[0:3], v[188:191], a[96:99], v[0:3]
    v_mfma_f32_16x16x32_bf16 v[4:7], v[188:191], a[100:103], v[4:7]
    v_exp_f32 v179, v179
    v_mfma_f32_16x16x32_bf16 v[4:7], v[184:187], a[68:71], v[4:7]
    v_cvt_pk_bf16_f32 v253, v178, v179
    v_mfma_f32_16x16x32_bf16 v[168:171], a[0:3], a[160:163], 0
    v_exp_f32 v180, v180
    v_mfma_f32_16x16x32_bf16 v[168:171], a[4:7], a[164:167], v[168:171]
    v_mfma_f32_16x16x32_bf16 v[168:171], a[8:11], a[168:171], v[168:171]
    v_exp_f32 v181, v181
    v_mfma_f32_16x16x32_bf16 v[168:171], a[12:15], a[172:175], v[168:171]
    v_cvt_pk_bf16_f32 v254, v180, v181
    v_mfma_f32_16x16x32_bf16 v[172:175], a[16:19], a[160:163], 0
    v_exp_f32 v182, v182
    v_mfma_f32_16x16x32_bf16 v[172:175], a[20:23], a[164:167], v[172:175]
    v_mfma_f32_16x16x32_bf16 v[172:175], a[24:27], a[168:171], v[172:175]
    v_exp_f32 v183, v183
    v_mfma_f32_16x16x32_bf16 v[172:175], a[28:31], a[172:175], v[172:175]
    v_cvt_pk_bf16_f32 v255, v182, v183
    v_mfma_f32_16x16x32_bf16 v[176:179], a[32:35], a[160:163], 0
    v_exp_f32 v168, v168
    v_mfma_f32_16x16x32_bf16 v[176:179], a[36:39], a[164:167], v[176:179]
    buffer_load_dwordx4 v225, s[12:15], s21 offen offset:1024 nt lds
    v_mfma_f32_16x16x32_bf16 v[176:179], a[40:43], a[168:171], v[176:179]
    v_exp_f32 v169, v169
    v_mfma_f32_16x16x32_bf16 v[176:179], a[44:47], a[172:175], v[176:179]
    v_cvt_pk_bf16_f32 v184, v168, v169
    v_mfma_f32_16x16x32_bf16 v[180:183], a[48:51], a[160:163], 0
    v_exp_f32 v170, v170
    v_mfma_f32_16x16x32_bf16 v[180:183], a[52:55], a[164:167], v[180:183]
    v_mfma_f32_16x16x32_bf16 v[180:183], a[56:59], a[168:171], v[180:183]
    v_exp_f32 v171, v171
    v_mfma_f32_16x16x32_bf16 v[180:183], a[60:63], a[172:175], v[180:183]
    v_cvt_pk_bf16_f32 v185, v170, v171
    v_smfmac_f32_16x16x64_bf16 v[234:237], a[252:255], v[248:255], v202
    v_mfma_f32_16x16x32_bf16 v[40:43], v[248:251], a[72:75], v[40:43]
    v_exp_f32 v172, v172
    v_mfma_f32_16x16x32_bf16 v[40:43], v[252:255], a[104:107], v[40:43]
    v_mfma_f32_16x16x32_bf16 v[44:47], v[252:255], a[108:111], v[44:47]
    v_exp_f32 v173, v173
    v_mfma_f32_16x16x32_bf16 v[44:47], v[248:251], a[76:79], v[44:47]
    v_cvt_pk_bf16_f32 v186, v172, v173
    v_mfma_f32_16x16x32_bf16 v[48:51], v[248:251], a[80:83], v[48:51]
    v_exp_f32 v174, v174
    v_mfma_f32_16x16x32_bf16 v[48:51], v[252:255], a[112:115], v[48:51]
    v_mfma_f32_16x16x32_bf16 v[52:55], v[252:255], a[116:119], v[52:55]
    v_exp_f32 v175, v175
    v_mfma_f32_16x16x32_bf16 v[52:55], v[248:251], a[84:87], v[52:55]
    v_cvt_pk_bf16_f32 v187, v174, v175
    v_mfma_f32_16x16x32_bf16 v[56:59], v[248:251], a[88:91], v[56:59]
    v_exp_f32 v176, v176
    v_mfma_f32_16x16x32_bf16 v[56:59], v[252:255], a[120:123], v[56:59]
    buffer_load_dwordx4 v224, s[12:15], s21 offen offset:2048 nt lds
    v_mfma_f32_16x16x32_bf16 v[60:63], v[252:255], a[124:127], v[60:63]
    v_exp_f32 v177, v177
    v_mfma_f32_16x16x32_bf16 v[60:63], v[248:251], a[92:95], v[60:63]
    v_cvt_pk_bf16_f32 v188, v176, v177
    v_mfma_f32_16x16x32_bf16 v[32:35], v[248:251], a[64:67], v[32:35]
    v_exp_f32 v178, v178
    v_mfma_f32_16x16x32_bf16 v[32:35], v[252:255], a[96:99], v[32:35]
    v_mfma_f32_16x16x32_bf16 v[36:39], v[252:255], a[100:103], v[36:39]
    v_exp_f32 v179, v179
    v_mfma_f32_16x16x32_bf16 v[36:39], v[248:251], a[68:71], v[36:39]
    v_cvt_pk_bf16_f32 v189, v178, v179
    v_mfma_f32_16x16x32_bf16 v[168:171], a[0:3], a[176:179], 0
    v_exp_f32 v180, v180
    v_mfma_f32_16x16x32_bf16 v[168:171], a[4:7], a[180:183], v[168:171]
    v_mfma_f32_16x16x32_bf16 v[168:171], a[8:11], a[184:187], v[168:171]
    v_exp_f32 v181, v181
    v_mfma_f32_16x16x32_bf16 v[168:171], a[12:15], a[188:191], v[168:171]
    v_cvt_pk_bf16_f32 v190, v180, v181
    v_mfma_f32_16x16x32_bf16 v[172:175], a[16:19], a[176:179], 0
    v_exp_f32 v182, v182
    v_mfma_f32_16x16x32_bf16 v[172:175], a[20:23], a[180:183], v[172:175]
    v_mfma_f32_16x16x32_bf16 v[172:175], a[24:27], a[184:187], v[172:175]
    v_exp_f32 v183, v183
    v_mfma_f32_16x16x32_bf16 v[172:175], a[28:31], a[188:191], v[172:175]
    v_cvt_pk_bf16_f32 v191, v182, v183
    v_mfma_f32_16x16x32_bf16 v[176:179], a[32:35], a[176:179], 0
    v_exp_f32 v168, v168
    v_mfma_f32_16x16x32_bf16 v[176:179], a[36:39], a[180:183], v[176:179]
    buffer_load_dwordx4 v225, s[12:15], s21 offen offset:3072 nt lds
    v_mfma_f32_16x16x32_bf16 v[176:179], a[40:43], a[184:187], v[176:179]
    v_exp_f32 v169, v169
    v_mfma_f32_16x16x32_bf16 v[176:179], a[44:47], a[188:191], v[176:179]
    v_cvt_pk_bf16_f32 v248, v168, v169
    v_mfma_f32_16x16x32_bf16 v[180:183], a[48:51], a[176:179], 0
    v_exp_f32 v170, v170
    v_mfma_f32_16x16x32_bf16 v[180:183], a[52:55], a[180:183], v[180:183]
    v_mfma_f32_16x16x32_bf16 v[180:183], a[56:59], a[184:187], v[180:183]
    v_exp_f32 v171, v171
    v_mfma_f32_16x16x32_bf16 v[180:183], a[60:63], a[188:191], v[180:183]
    v_cvt_pk_bf16_f32 v249, v170, v171
    v_smfmac_f32_16x16x64_bf16 v[238:241], a[248:251], v[184:191], v202
    v_mfma_f32_16x16x32_bf16 v[72:75], v[184:187], a[72:75], v[72:75]
    v_exp_f32 v172, v172
    v_mfma_f32_16x16x32_bf16 v[72:75], v[188:191], a[104:107], v[72:75]
    v_mfma_f32_16x16x32_bf16 v[76:79], v[188:191], a[108:111], v[76:79]
    v_exp_f32 v173, v173
    v_mfma_f32_16x16x32_bf16 v[76:79], v[184:187], a[76:79], v[76:79]
    v_cvt_pk_bf16_f32 v250, v172, v173
    v_mfma_f32_16x16x32_bf16 v[80:83], v[184:187], a[80:83], v[80:83]
    v_exp_f32 v174, v174
    v_mfma_f32_16x16x32_bf16 v[80:83], v[188:191], a[112:115], v[80:83]
    v_mfma_f32_16x16x32_bf16 v[84:87], v[188:191], a[116:119], v[84:87]
    v_exp_f32 v175, v175
    v_mfma_f32_16x16x32_bf16 v[84:87], v[184:187], a[84:87], v[84:87]
    v_cvt_pk_bf16_f32 v251, v174, v175
    v_mfma_f32_16x16x32_bf16 v[88:91], v[184:187], a[88:91], v[88:91]
    v_exp_f32 v176, v176
    v_mfma_f32_16x16x32_bf16 v[88:91], v[188:191], a[120:123], v[88:91]
    v_mfma_f32_16x16x32_bf16 v[92:95], v[188:191], a[124:127], v[92:95]
    v_exp_f32 v177, v177
    v_mfma_f32_16x16x32_bf16 v[92:95], v[184:187], a[92:95], v[92:95]
    v_cvt_pk_bf16_f32 v252, v176, v177
    v_mfma_f32_16x16x32_bf16 v[64:67], v[184:187], a[64:67], v[64:67]
    v_exp_f32 v178, v178
    v_mfma_f32_16x16x32_bf16 v[64:67], v[188:191], a[96:99], v[64:67]
    v_mfma_f32_16x16x32_bf16 v[68:71], v[188:191], a[100:103], v[68:71]
    v_exp_f32 v179, v179
    v_mfma_f32_16x16x32_bf16 v[68:71], v[184:187], a[68:71], v[68:71]
    v_cvt_pk_bf16_f32 v253, v178, v179
    s_add_u32 s21, s21, 16384
    s_waitcnt vmcnt(8) lgkmcnt(15)
    s_barrier
    v_mfma_f32_16x16x32_bf16 v[168:171], a[0:3], a[192:195], 0
    v_exp_f32 v180, v180
    v_mfma_f32_16x16x32_bf16 v[168:171], a[4:7], a[196:199], v[168:171]
    ds_read_b128 a[224:227], v216 offset:16384
    v_mfma_f32_16x16x32_bf16 v[168:171], a[8:11], a[200:203], v[168:171]
    v_exp_f32 v181, v181
    v_mfma_f32_16x16x32_bf16 v[168:171], a[12:15], a[204:207], v[168:171]
    ds_read_b128 a[228:231], v217 offset:16384
    v_cvt_pk_bf16_f32 v254, v180, v181
    v_mfma_f32_16x16x32_bf16 v[172:175], a[16:19], a[192:195], 0
    v_exp_f32 v182, v182
    v_mfma_f32_16x16x32_bf16 v[172:175], a[20:23], a[196:199], v[172:175]
    ds_read_b128 a[232:235], v218 offset:16384
    v_mfma_f32_16x16x32_bf16 v[172:175], a[24:27], a[200:203], v[172:175]
    v_exp_f32 v183, v183
    v_mfma_f32_16x16x32_bf16 v[172:175], a[28:31], a[204:207], v[172:175]
    ds_read_b128 a[236:239], v219 offset:16384
    v_cvt_pk_bf16_f32 v255, v182, v183
    v_mfma_f32_16x16x32_bf16 v[176:179], a[32:35], a[192:195], 0
    v_exp_f32 v168, v168
    v_mfma_f32_16x16x32_bf16 v[176:179], a[36:39], a[196:199], v[176:179]
    ds_read_b128 a[0:3], v204 offset:16384
    v_mfma_f32_16x16x32_bf16 v[176:179], a[40:43], a[200:203], v[176:179]
    v_exp_f32 v169, v169
    v_mfma_f32_16x16x32_bf16 v[176:179], a[44:47], a[204:207], v[176:179]
    ds_read_b128 a[4:7], v205 offset:16384
    v_cvt_pk_bf16_f32 v184, v168, v169
    v_mfma_f32_16x16x32_bf16 v[180:183], a[48:51], a[192:195], 0
    v_exp_f32 v170, v170
    v_mfma_f32_16x16x32_bf16 v[180:183], a[52:55], a[196:199], v[180:183]
    ds_read_b128 a[8:11], v206 offset:16384
    v_mfma_f32_16x16x32_bf16 v[180:183], a[56:59], a[200:203], v[180:183]
    v_exp_f32 v171, v171
    v_mfma_f32_16x16x32_bf16 v[180:183], a[60:63], a[204:207], v[180:183]
    ds_read_b128 a[12:15], v207 offset:16384
    v_cvt_pk_bf16_f32 v185, v170, v171
    v_smfmac_f32_16x16x64_bf16 v[238:241], a[252:255], v[248:255], v202
    ds_read_b128 a[16:19], v204 offset:20480
    v_mfma_f32_16x16x32_bf16 v[104:107], v[248:251], a[72:75], v[104:107]
    v_exp_f32 v172, v172
    v_mfma_f32_16x16x32_bf16 v[104:107], v[252:255], a[104:107], v[104:107]
    ds_read_b128 a[20:23], v205 offset:20480
    v_mfma_f32_16x16x32_bf16 v[108:111], v[252:255], a[108:111], v[108:111]
    v_exp_f32 v173, v173
    v_mfma_f32_16x16x32_bf16 v[108:111], v[248:251], a[76:79], v[108:111]
    ds_read_b128 a[24:27], v206 offset:20480
    v_cvt_pk_bf16_f32 v186, v172, v173
    v_mfma_f32_16x16x32_bf16 v[112:115], v[248:251], a[80:83], v[112:115]
    v_exp_f32 v174, v174
    v_mfma_f32_16x16x32_bf16 v[112:115], v[252:255], a[112:115], v[112:115]
    ds_read_b128 a[28:31], v207 offset:20480
    v_mfma_f32_16x16x32_bf16 v[116:119], v[252:255], a[116:119], v[116:119]
    v_exp_f32 v175, v175
    v_mfma_f32_16x16x32_bf16 v[116:119], v[248:251], a[84:87], v[116:119]
    ds_read_b128 a[32:35], v204 offset:24576
    v_cvt_pk_bf16_f32 v187, v174, v175
    v_mfma_f32_16x16x32_bf16 v[120:123], v[248:251], a[88:91], v[120:123]
    v_exp_f32 v176, v176
    v_mfma_f32_16x16x32_bf16 v[120:123], v[252:255], a[120:123], v[120:123]
    ds_read_b128 a[36:39], v205 offset:24576
    v_mfma_f32_16x16x32_bf16 v[124:127], v[252:255], a[124:127], v[124:127]
    v_exp_f32 v177, v177
    v_mfma_f32_16x16x32_bf16 v[124:127], v[248:251], a[92:95], v[124:127]
    ds_read_b128 a[40:43], v206 offset:24576
    v_cvt_pk_bf16_f32 v188, v176, v177
    v_mfma_f32_16x16x32_bf16 v[96:99], v[248:251], a[64:67], v[96:99]
    v_exp_f32 v178, v178
    v_mfma_f32_16x16x32_bf16 v[96:99], v[252:255], a[96:99], v[96:99]
    ds_read_b128 a[44:47], v207 offset:24576
    v_mfma_f32_16x16x32_bf16 v[100:103], v[252:255], a[100:103], v[100:103]
    v_exp_f32 v179, v179
    v_mfma_f32_16x16x32_bf16 v[100:103], v[248:251], a[68:71], v[100:103]
    s_waitcnt lgkmcnt(3)
    ds_read_b128 a[48:51], v204 offset:28672
    v_cvt_pk_bf16_f32 v189, v178, v179
    v_mfma_f32_16x16x32_bf16 v[192:195], a[224:227], a[208:211], 0
    ds_read_b128 a[52:55], v205 offset:28672
    v_mfma_f32_16x16x32_bf16 v[192:195], a[228:231], a[212:215], v[192:195]
    ds_read_b128 a[56:59], v206 offset:28672
    v_mfma_f32_16x16x32_bf16 v[192:195], a[232:235], a[216:219], v[192:195]
    ds_read_b128 a[60:63], v207 offset:28672
    s_add_u32 m0, s22, 49152
    v_mfma_f32_16x16x32_bf16 v[192:195], a[236:239], a[220:223], v[192:195]
    buffer_load_dwordx4 v220, s[8:11], s21 offen nt lds
    v_mfma_f32_16x16x32_bf16 v[168:171], a[0:3], a[128:131], 0
    v_exp_f32 v180, v180
    v_mfma_f32_16x16x32_bf16 v[168:171], a[4:7], a[132:135], v[168:171]
    ds_read_b128 a[240:243], v227 offset:0
    v_mfma_f32_16x16x32_bf16 v[168:171], a[8:11], a[136:139], v[168:171]
    v_exp_f32 v181, v181
    v_mfma_f32_16x16x32_bf16 v[168:171], a[12:15], a[140:143], v[168:171]
    ds_read_b128 a[244:247], v227 offset:1024
    v_cvt_pk_bf16_f32 v190, v180, v181
    v_mfma_f32_16x16x32_bf16 v[172:175], a[16:19], a[128:131], 0
    v_exp_f32 v182, v182
    v_mfma_f32_16x16x32_bf16 v[172:175], a[20:23], a[132:135], v[172:175]
    v_exp_f32 v192, v192
    v_mfma_f32_16x16x32_bf16 v[172:175], a[24:27], a[136:139], v[172:175]
    v_exp_f32 v183, v183
    v_mfma_f32_16x16x32_bf16 v[172:175], a[28:31], a[140:143], v[172:175]
    v_cvt_pk_bf16_f32 v191, v182, v183
    v_mfma_f32_16x16x32_bf16 v[176:179], a[32:35], a[128:131], 0
    s_waitcnt lgkmcnt(1)
    v_exp_f32 v168, v168
    v_mfma_f32_16x16x32_bf16 v[176:179], a[36:39], a[132:135], v[176:179]
    v_exp_f32 v193, v193
    v_mfma_f32_16x16x32_bf16 v[176:179], a[40:43], a[136:139], v[176:179]
    v_exp_f32 v169, v169
    v_mfma_f32_16x16x32_bf16 v[176:179], a[44:47], a[140:143], v[176:179]
    v_cvt_pk_bf16_f32 v248, v168, v169
    v_cvt_pk_bf16_f32 v196, v192, v193
    v_mfma_f32_16x16x32_bf16 v[180:183], a[48:51], a[128:131], 0
    v_exp_f32 v170, v170
    v_mfma_f32_16x16x32_bf16 v[180:183], a[52:55], a[132:135], v[180:183]
    v_exp_f32 v194, v194
    v_mfma_f32_16x16x32_bf16 v[180:183], a[56:59], a[136:139], v[180:183]
    v_exp_f32 v171, v171
    v_mfma_f32_16x16x32_bf16 v[180:183], a[60:63], a[140:143], v[180:183]
    v_cvt_pk_bf16_f32 v249, v170, v171
    v_smfmac_f32_16x16x64_bf16 v[230:233], a[248:251], v[184:191], v202
    v_exp_f32 v195, v195
    v_mfma_f32_16x16x32_bf16 v[136:139], v[184:187], a[72:75], v[136:139]
    v_exp_f32 v172, v172
    v_mfma_f32_16x16x32_bf16 v[136:139], v[188:191], a[104:107], v[136:139]
    ds_read_b64_tr_b16 a[72:73], v210 offset:16384
    v_cvt_pk_bf16_f32 v197, v194, v195
    v_mfma_f32_16x16x32_bf16 v[140:143], v[188:191], a[108:111], v[140:143]
    v_exp_f32 v173, v173
    v_mfma_f32_16x16x32_bf16 v[140:143], v[184:187], a[76:79], v[140:143]
    ds_read_b64_tr_b16 a[74:75], v210 offset:20480
    v_cvt_pk_bf16_f32 v250, v172, v173
    v_mfma_f32_16x16x32_bf16 v[144:147], v[184:187], a[80:83], v[144:147]
    v_exp_f32 v174, v174
    v_mfma_f32_16x16x32_bf16 v[144:147], v[188:191], a[112:115], v[144:147]
    buffer_load_dwordx4 v221, s[8:11], s21 offen offset:1024 nt lds
    v_mfma_f32_16x16x32_bf16 v[148:151], v[188:191], a[116:119], v[148:151]
    v_exp_f32 v175, v175
    v_mfma_f32_16x16x32_bf16 v[148:151], v[184:187], a[84:87], v[148:151]
    ds_read_b64_tr_b16 a[104:105], v210 offset:24576
    v_cvt_pk_bf16_f32 v251, v174, v175
    v_mfma_f32_16x16x32_bf16 v[152:155], v[184:187], a[88:91], v[152:155]
    v_exp_f32 v176, v176
    v_mfma_f32_16x16x32_bf16 v[152:155], v[188:191], a[120:123], v[152:155]
    ds_read_b64_tr_b16 a[106:107], v210 offset:28672
    ds_read_b64_tr_b16 a[108:109], v211 offset:24576
    v_mfma_f32_16x16x32_bf16 v[156:159], v[188:191], a[124:127], v[156:159]
    v_exp_f32 v177, v177
    v_mfma_f32_16x16x32_bf16 v[156:159], v[184:187], a[92:95], v[156:159]
    ds_read_b64_tr_b16 a[110:111], v211 offset:28672
    v_cvt_pk_bf16_f32 v252, v176, v177
    v_mfma_f32_16x16x32_bf16 v[128:131], v[184:187], a[64:67], v[128:131]
    v_exp_f32 v178, v178
    v_mfma_f32_16x16x32_bf16 v[128:131], v[188:191], a[96:99], v[128:131]
    ds_read_b64_tr_b16 a[76:77], v211 offset:16384
    ds_read_b64_tr_b16 a[78:79], v211 offset:20480
    v_mfma_f32_16x16x32_bf16 v[132:135], v[188:191], a[100:103], v[132:135]
    v_exp_f32 v179, v179
    v_mfma_f32_16x16x32_bf16 v[132:135], v[184:187], a[68:71], v[132:135]
    s_waitcnt lgkmcnt(4)
    ds_read_b64_tr_b16 a[80:81], v212 offset:16384
    v_cvt_pk_bf16_f32 v253, v178, v179
    v_smfmac_f32_16x16x64_bf16 v[230:233], a[252:255], a[240:247], v202
    ds_write_b64 v226, v[196:197] offset:2048
    v_mfma_f32_16x16x32_bf16 v[160:163], a[240:243], a[64:67], v[160:163]
    ds_read_b64_tr_b16 a[82:83], v212 offset:20480
    ds_read_b64_tr_b16 a[112:113], v212 offset:24576
    v_mfma_f32_16x16x32_bf16 v[160:163], a[244:247], a[96:99], v[160:163]
    ds_read_b64_tr_b16 a[114:115], v212 offset:28672
    ds_read_b64_tr_b16 a[116:117], v213 offset:24576
    v_mfma_f32_16x16x32_bf16 v[164:167], a[244:247], a[100:103], v[164:167]
    ds_read_b64_tr_b16 a[118:119], v213 offset:28672
    ds_read_b64_tr_b16 a[84:85], v213 offset:16384
    v_mfma_f32_16x16x32_bf16 v[164:167], a[240:243], a[68:71], v[164:167]
    ds_read_b64_tr_b16 a[86:87], v213 offset:20480
    ds_read_b64_tr_b16 a[88:89], v214 offset:16384
    v_mfma_f32_16x16x32_bf16 v[168:171], a[0:3], a[144:147], 0
    v_exp_f32 v180, v180
    v_mfma_f32_16x16x32_bf16 v[168:171], a[4:7], a[148:151], v[168:171]
    buffer_load_dwordx4 v222, s[8:11], s21 offen offset:2048 nt lds
    v_mfma_f32_16x16x32_bf16 v[168:171], a[8:11], a[152:155], v[168:171]
    v_exp_f32 v181, v181
    v_mfma_f32_16x16x32_bf16 v[168:171], a[12:15], a[156:159], v[168:171]
    ds_read_b64_tr_b16 a[90:91], v214 offset:20480
    v_cvt_pk_bf16_f32 v254, v180, v181
    v_mfma_f32_16x16x32_bf16 v[172:175], a[16:19], a[144:147], 0
    v_exp_f32 v182, v182
    v_mfma_f32_16x16x32_bf16 v[172:175], a[20:23], a[148:151], v[172:175]
    ds_read_b64_tr_b16 a[120:121], v214 offset:24576
    ds_read_b64_tr_b16 a[122:123], v214 offset:28672
    v_mfma_f32_16x16x32_bf16 v[172:175], a[24:27], a[152:155], v[172:175]
    v_exp_f32 v183, v183
    v_mfma_f32_16x16x32_bf16 v[172:175], a[28:31], a[156:159], v[172:175]
    ds_read_b64_tr_b16 a[124:125], v215 offset:24576
    v_cvt_pk_bf16_f32 v255, v182, v183
    v_mfma_f32_16x16x32_bf16 v[176:179], a[32:35], a[144:147], 0
    v_exp_f32 v168, v168
    v_mfma_f32_16x16x32_bf16 v[176:179], a[36:39], a[148:151], v[176:179]
    ds_read_b64_tr_b16 a[126:127], v215 offset:28672
    ds_read_b64_tr_b16 a[92:93], v215 offset:16384
    v_mfma_f32_16x16x32_bf16 v[176:179], a[40:43], a[152:155], v[176:179]
    v_exp_f32 v169, v169
    v_mfma_f32_16x16x32_bf16 v[176:179], a[44:47], a[156:159], v[176:179]
    ds_read_b64_tr_b16 a[94:95], v215 offset:20480
    v_cvt_pk_bf16_f32 v184, v168, v169
    v_mfma_f32_16x16x32_bf16 v[180:183], a[48:51], a[144:147], 0
    v_exp_f32 v170, v170
    v_mfma_f32_16x16x32_bf16 v[180:183], a[52:55], a[148:151], v[180:183]
    ds_read_b64_tr_b16 a[64:65], v208 offset:16384
    ds_read_b64_tr_b16 a[66:67], v208 offset:20480
    v_mfma_f32_16x16x32_bf16 v[180:183], a[56:59], a[152:155], v[180:183]
    v_exp_f32 v171, v171
    v_mfma_f32_16x16x32_bf16 v[180:183], a[60:63], a[156:159], v[180:183]
    ds_read_b64_tr_b16 a[96:97], v208 offset:24576
    v_cvt_pk_bf16_f32 v185, v170, v171
    v_smfmac_f32_16x16x64_bf16 v[234:237], a[248:251], v[248:255], v202
    ds_read_b64_tr_b16 a[98:99], v208 offset:28672
    ds_read_b64_tr_b16 a[100:101], v209 offset:24576
    v_mfma_f32_16x16x32_bf16 v[8:11], v[248:251], a[72:75], v[8:11]
    v_exp_f32 v172, v172
    v_mfma_f32_16x16x32_bf16 v[8:11], v[252:255], a[104:107], v[8:11]
    s_waitcnt lgkmcnt(5)
    ds_read_b64_tr_b16 a[102:103], v209 offset:28672
    ds_read_b64_tr_b16 a[68:69], v209 offset:16384
    v_mfma_f32_16x16x32_bf16 v[12:15], v[252:255], a[108:111], v[12:15]
    v_exp_f32 v173, v173
    v_mfma_f32_16x16x32_bf16 v[12:15], v[248:251], a[76:79], v[12:15]
    ds_read_b64_tr_b16 a[70:71], v209 offset:20480
    v_cvt_pk_bf16_f32 v186, v172, v173
    v_mfma_f32_16x16x32_bf16 v[16:19], v[248:251], a[80:83], v[16:19]
    v_exp_f32 v174, v174
    v_mfma_f32_16x16x32_bf16 v[16:19], v[252:255], a[112:115], v[16:19]
    buffer_load_dwordx4 v223, s[8:11], s21 offen offset:3072 nt lds
    v_mfma_f32_16x16x32_bf16 v[20:23], v[252:255], a[116:119], v[20:23]
    v_exp_f32 v175, v175
    v_mfma_f32_16x16x32_bf16 v[20:23], v[248:251], a[84:87], v[20:23]
    v_cvt_pk_bf16_f32 v187, v174, v175
    v_mfma_f32_16x16x32_bf16 v[24:27], v[248:251], a[88:91], v[24:27]
    v_exp_f32 v176, v176
    s_add_u32 m0, s22, 114688
    v_mfma_f32_16x16x32_bf16 v[24:27], v[252:255], a[120:123], v[24:27]
    buffer_load_dwordx4 v224, s[12:15], s21 offen nt lds
    v_mfma_f32_16x16x32_bf16 v[28:31], v[252:255], a[124:127], v[28:31]
    v_exp_f32 v177, v177
    v_mfma_f32_16x16x32_bf16 v[28:31], v[248:251], a[92:95], v[28:31]
    s_waitcnt lgkmcnt(0)
    v_cvt_pk_bf16_f32 v188, v176, v177
    v_mfma_f32_16x16x32_bf16 v[0:3], v[248:251], a[64:67], v[0:3]
    v_exp_f32 v178, v178
    v_mfma_f32_16x16x32_bf16 v[0:3], v[252:255], a[96:99], v[0:3]
    v_mfma_f32_16x16x32_bf16 v[4:7], v[252:255], a[100:103], v[4:7]
    v_exp_f32 v179, v179
    v_mfma_f32_16x16x32_bf16 v[4:7], v[248:251], a[68:71], v[4:7]
    v_cvt_pk_bf16_f32 v189, v178, v179
    v_mfma_f32_16x16x32_bf16 v[168:171], a[0:3], a[160:163], 0
    v_exp_f32 v180, v180
    v_mfma_f32_16x16x32_bf16 v[168:171], a[4:7], a[164:167], v[168:171]
    v_mfma_f32_16x16x32_bf16 v[168:171], a[8:11], a[168:171], v[168:171]
    v_exp_f32 v181, v181
    v_mfma_f32_16x16x32_bf16 v[168:171], a[12:15], a[172:175], v[168:171]
    v_cvt_pk_bf16_f32 v190, v180, v181
    v_mfma_f32_16x16x32_bf16 v[172:175], a[16:19], a[160:163], 0
    v_exp_f32 v182, v182
    v_mfma_f32_16x16x32_bf16 v[172:175], a[20:23], a[164:167], v[172:175]
    v_mfma_f32_16x16x32_bf16 v[172:175], a[24:27], a[168:171], v[172:175]
    v_exp_f32 v183, v183
    v_mfma_f32_16x16x32_bf16 v[172:175], a[28:31], a[172:175], v[172:175]
    v_cvt_pk_bf16_f32 v191, v182, v183
    v_mfma_f32_16x16x32_bf16 v[176:179], a[32:35], a[160:163], 0
    v_exp_f32 v168, v168
    v_mfma_f32_16x16x32_bf16 v[176:179], a[36:39], a[164:167], v[176:179]
    buffer_load_dwordx4 v225, s[12:15], s21 offen offset:1024 nt lds
    v_mfma_f32_16x16x32_bf16 v[176:179], a[40:43], a[168:171], v[176:179]
    v_exp_f32 v169, v169
    v_mfma_f32_16x16x32_bf16 v[176:179], a[44:47], a[172:175], v[176:179]
    v_cvt_pk_bf16_f32 v248, v168, v169
    v_mfma_f32_16x16x32_bf16 v[180:183], a[48:51], a[160:163], 0
    v_exp_f32 v170, v170
    v_mfma_f32_16x16x32_bf16 v[180:183], a[52:55], a[164:167], v[180:183]
    v_mfma_f32_16x16x32_bf16 v[180:183], a[56:59], a[168:171], v[180:183]
    v_exp_f32 v171, v171
    v_mfma_f32_16x16x32_bf16 v[180:183], a[60:63], a[172:175], v[180:183]
    v_cvt_pk_bf16_f32 v249, v170, v171
    v_smfmac_f32_16x16x64_bf16 v[234:237], a[252:255], v[184:191], v202
    v_mfma_f32_16x16x32_bf16 v[40:43], v[184:187], a[72:75], v[40:43]
    v_exp_f32 v172, v172
    v_mfma_f32_16x16x32_bf16 v[40:43], v[188:191], a[104:107], v[40:43]
    v_mfma_f32_16x16x32_bf16 v[44:47], v[188:191], a[108:111], v[44:47]
    v_exp_f32 v173, v173
    v_mfma_f32_16x16x32_bf16 v[44:47], v[184:187], a[76:79], v[44:47]
    v_cvt_pk_bf16_f32 v250, v172, v173
    v_mfma_f32_16x16x32_bf16 v[48:51], v[184:187], a[80:83], v[48:51]
    v_exp_f32 v174, v174
    v_mfma_f32_16x16x32_bf16 v[48:51], v[188:191], a[112:115], v[48:51]
    v_mfma_f32_16x16x32_bf16 v[52:55], v[188:191], a[116:119], v[52:55]
    v_exp_f32 v175, v175
    v_mfma_f32_16x16x32_bf16 v[52:55], v[184:187], a[84:87], v[52:55]
    v_cvt_pk_bf16_f32 v251, v174, v175
    v_mfma_f32_16x16x32_bf16 v[56:59], v[184:187], a[88:91], v[56:59]
    v_exp_f32 v176, v176
    v_mfma_f32_16x16x32_bf16 v[56:59], v[188:191], a[120:123], v[56:59]
    buffer_load_dwordx4 v224, s[12:15], s21 offen offset:2048 nt lds
    v_mfma_f32_16x16x32_bf16 v[60:63], v[188:191], a[124:127], v[60:63]
    v_exp_f32 v177, v177
    v_mfma_f32_16x16x32_bf16 v[60:63], v[184:187], a[92:95], v[60:63]
    v_cvt_pk_bf16_f32 v252, v176, v177
    v_mfma_f32_16x16x32_bf16 v[32:35], v[184:187], a[64:67], v[32:35]
    v_exp_f32 v178, v178
    v_mfma_f32_16x16x32_bf16 v[32:35], v[188:191], a[96:99], v[32:35]
    v_mfma_f32_16x16x32_bf16 v[36:39], v[188:191], a[100:103], v[36:39]
    v_exp_f32 v179, v179
    v_mfma_f32_16x16x32_bf16 v[36:39], v[184:187], a[68:71], v[36:39]
    v_cvt_pk_bf16_f32 v253, v178, v179
    v_mfma_f32_16x16x32_bf16 v[168:171], a[0:3], a[176:179], 0
    v_exp_f32 v180, v180
    v_mfma_f32_16x16x32_bf16 v[168:171], a[4:7], a[180:183], v[168:171]
    v_mfma_f32_16x16x32_bf16 v[168:171], a[8:11], a[184:187], v[168:171]
    v_exp_f32 v181, v181
    v_mfma_f32_16x16x32_bf16 v[168:171], a[12:15], a[188:191], v[168:171]
    v_cvt_pk_bf16_f32 v254, v180, v181
    v_mfma_f32_16x16x32_bf16 v[172:175], a[16:19], a[176:179], 0
    v_exp_f32 v182, v182
    v_mfma_f32_16x16x32_bf16 v[172:175], a[20:23], a[180:183], v[172:175]
    v_mfma_f32_16x16x32_bf16 v[172:175], a[24:27], a[184:187], v[172:175]
    v_exp_f32 v183, v183
    v_mfma_f32_16x16x32_bf16 v[172:175], a[28:31], a[188:191], v[172:175]
    v_cvt_pk_bf16_f32 v255, v182, v183
    v_mfma_f32_16x16x32_bf16 v[176:179], a[32:35], a[176:179], 0
    v_exp_f32 v168, v168
    v_mfma_f32_16x16x32_bf16 v[176:179], a[36:39], a[180:183], v[176:179]
    buffer_load_dwordx4 v225, s[12:15], s21 offen offset:3072 nt lds
    v_mfma_f32_16x16x32_bf16 v[176:179], a[40:43], a[184:187], v[176:179]
    v_exp_f32 v169, v169
    v_mfma_f32_16x16x32_bf16 v[176:179], a[44:47], a[188:191], v[176:179]
    v_cvt_pk_bf16_f32 v184, v168, v169
    v_mfma_f32_16x16x32_bf16 v[180:183], a[48:51], a[176:179], 0
    v_exp_f32 v170, v170
    v_mfma_f32_16x16x32_bf16 v[180:183], a[52:55], a[180:183], v[180:183]
    v_mfma_f32_16x16x32_bf16 v[180:183], a[56:59], a[184:187], v[180:183]
    v_exp_f32 v171, v171
    v_mfma_f32_16x16x32_bf16 v[180:183], a[60:63], a[188:191], v[180:183]
    v_cvt_pk_bf16_f32 v185, v170, v171
    v_smfmac_f32_16x16x64_bf16 v[238:241], a[248:251], v[248:255], v202
    v_mfma_f32_16x16x32_bf16 v[72:75], v[248:251], a[72:75], v[72:75]
    v_exp_f32 v172, v172
    v_mfma_f32_16x16x32_bf16 v[72:75], v[252:255], a[104:107], v[72:75]
    v_mfma_f32_16x16x32_bf16 v[76:79], v[252:255], a[108:111], v[76:79]
    v_exp_f32 v173, v173
    v_mfma_f32_16x16x32_bf16 v[76:79], v[248:251], a[76:79], v[76:79]
    v_cvt_pk_bf16_f32 v186, v172, v173
    v_mfma_f32_16x16x32_bf16 v[80:83], v[248:251], a[80:83], v[80:83]
    v_exp_f32 v174, v174
    v_mfma_f32_16x16x32_bf16 v[80:83], v[252:255], a[112:115], v[80:83]
    v_mfma_f32_16x16x32_bf16 v[84:87], v[252:255], a[116:119], v[84:87]
    v_exp_f32 v175, v175
    v_mfma_f32_16x16x32_bf16 v[84:87], v[248:251], a[84:87], v[84:87]
    v_cvt_pk_bf16_f32 v187, v174, v175
    v_mfma_f32_16x16x32_bf16 v[88:91], v[248:251], a[88:91], v[88:91]
    v_exp_f32 v176, v176
    v_mfma_f32_16x16x32_bf16 v[88:91], v[252:255], a[120:123], v[88:91]
    v_mfma_f32_16x16x32_bf16 v[92:95], v[252:255], a[124:127], v[92:95]
    v_exp_f32 v177, v177
    v_mfma_f32_16x16x32_bf16 v[92:95], v[248:251], a[92:95], v[92:95]
    v_cvt_pk_bf16_f32 v188, v176, v177
    v_mfma_f32_16x16x32_bf16 v[64:67], v[248:251], a[64:67], v[64:67]
    v_exp_f32 v178, v178
    v_mfma_f32_16x16x32_bf16 v[64:67], v[252:255], a[96:99], v[64:67]
    v_mfma_f32_16x16x32_bf16 v[68:71], v[252:255], a[100:103], v[68:71]
    v_exp_f32 v179, v179
    v_mfma_f32_16x16x32_bf16 v[68:71], v[248:251], a[68:71], v[68:71]
    v_cvt_pk_bf16_f32 v189, v178, v179
    s_add_u32 s21, s21, 16384
    s_waitcnt vmcnt(8) lgkmcnt(15)
    s_barrier
    v_mfma_f32_16x16x32_bf16 v[168:171], a[0:3], a[192:195], 0
    v_exp_f32 v180, v180
    v_mfma_f32_16x16x32_bf16 v[168:171], a[4:7], a[196:199], v[168:171]
    ds_read_b128 a[224:227], v216 offset:32768
    v_mfma_f32_16x16x32_bf16 v[168:171], a[8:11], a[200:203], v[168:171]
    v_exp_f32 v181, v181
    v_mfma_f32_16x16x32_bf16 v[168:171], a[12:15], a[204:207], v[168:171]
    ds_read_b128 a[228:231], v217 offset:32768
    v_cvt_pk_bf16_f32 v190, v180, v181
    v_mfma_f32_16x16x32_bf16 v[172:175], a[16:19], a[192:195], 0
    v_exp_f32 v182, v182
    v_mfma_f32_16x16x32_bf16 v[172:175], a[20:23], a[196:199], v[172:175]
    ds_read_b128 a[232:235], v218 offset:32768
    v_mfma_f32_16x16x32_bf16 v[172:175], a[24:27], a[200:203], v[172:175]
    v_exp_f32 v183, v183
    v_mfma_f32_16x16x32_bf16 v[172:175], a[28:31], a[204:207], v[172:175]
    ds_read_b128 a[236:239], v219 offset:32768
    v_cvt_pk_bf16_f32 v191, v182, v183
    v_mfma_f32_16x16x32_bf16 v[176:179], a[32:35], a[192:195], 0
    v_exp_f32 v168, v168
    v_mfma_f32_16x16x32_bf16 v[176:179], a[36:39], a[196:199], v[176:179]
    ds_read_b128 a[0:3], v204 offset:32768
    v_mfma_f32_16x16x32_bf16 v[176:179], a[40:43], a[200:203], v[176:179]
    v_exp_f32 v169, v169
    v_mfma_f32_16x16x32_bf16 v[176:179], a[44:47], a[204:207], v[176:179]
    ds_read_b128 a[4:7], v205 offset:32768
    v_cvt_pk_bf16_f32 v248, v168, v169
    v_mfma_f32_16x16x32_bf16 v[180:183], a[48:51], a[192:195], 0
    v_exp_f32 v170, v170
    v_mfma_f32_16x16x32_bf16 v[180:183], a[52:55], a[196:199], v[180:183]
    ds_read_b128 a[8:11], v206 offset:32768
    v_mfma_f32_16x16x32_bf16 v[180:183], a[56:59], a[200:203], v[180:183]
    v_exp_f32 v171, v171
    v_mfma_f32_16x16x32_bf16 v[180:183], a[60:63], a[204:207], v[180:183]
    ds_read_b128 a[12:15], v207 offset:32768
    v_cvt_pk_bf16_f32 v249, v170, v171
    v_smfmac_f32_16x16x64_bf16 v[238:241], a[252:255], v[184:191], v202
    ds_read_b128 a[16:19], v204 offset:36864
    v_mfma_f32_16x16x32_bf16 v[104:107], v[184:187], a[72:75], v[104:107]
    v_exp_f32 v172, v172
    v_mfma_f32_16x16x32_bf16 v[104:107], v[188:191], a[104:107], v[104:107]
    ds_read_b128 a[20:23], v205 offset:36864
    v_mfma_f32_16x16x32_bf16 v[108:111], v[188:191], a[108:111], v[108:111]
    v_exp_f32 v173, v173
    v_mfma_f32_16x16x32_bf16 v[108:111], v[184:187], a[76:79], v[108:111]
    ds_read_b128 a[24:27], v206 offset:36864
    v_cvt_pk_bf16_f32 v250, v172, v173
    v_mfma_f32_16x16x32_bf16 v[112:115], v[184:187], a[80:83], v[112:115]
    v_exp_f32 v174, v174
    v_mfma_f32_16x16x32_bf16 v[112:115], v[188:191], a[112:115], v[112:115]
    ds_read_b128 a[28:31], v207 offset:36864
    v_mfma_f32_16x16x32_bf16 v[116:119], v[188:191], a[116:119], v[116:119]
    v_exp_f32 v175, v175
    v_mfma_f32_16x16x32_bf16 v[116:119], v[184:187], a[84:87], v[116:119]
    ds_read_b128 a[32:35], v204 offset:40960
    v_cvt_pk_bf16_f32 v251, v174, v175
    v_mfma_f32_16x16x32_bf16 v[120:123], v[184:187], a[88:91], v[120:123]
    v_exp_f32 v176, v176
    v_mfma_f32_16x16x32_bf16 v[120:123], v[188:191], a[120:123], v[120:123]
    ds_read_b128 a[36:39], v205 offset:40960
    v_mfma_f32_16x16x32_bf16 v[124:127], v[188:191], a[124:127], v[124:127]
    v_exp_f32 v177, v177
    v_mfma_f32_16x16x32_bf16 v[124:127], v[184:187], a[92:95], v[124:127]
    ds_read_b128 a[40:43], v206 offset:40960
    v_cvt_pk_bf16_f32 v252, v176, v177
    v_mfma_f32_16x16x32_bf16 v[96:99], v[184:187], a[64:67], v[96:99]
    v_exp_f32 v178, v178
    v_mfma_f32_16x16x32_bf16 v[96:99], v[188:191], a[96:99], v[96:99]
    ds_read_b128 a[44:47], v207 offset:40960
    v_mfma_f32_16x16x32_bf16 v[100:103], v[188:191], a[100:103], v[100:103]
    v_exp_f32 v179, v179
    v_mfma_f32_16x16x32_bf16 v[100:103], v[184:187], a[68:71], v[100:103]
    s_waitcnt lgkmcnt(3)
    ds_read_b128 a[48:51], v204 offset:45056
    v_cvt_pk_bf16_f32 v253, v178, v179
    v_mfma_f32_16x16x32_bf16 v[192:195], a[224:227], a[208:211], 0
    ds_read_b128 a[52:55], v205 offset:45056
    v_mfma_f32_16x16x32_bf16 v[192:195], a[228:231], a[212:215], v[192:195]
    ds_read_b128 a[56:59], v206 offset:45056
    v_mfma_f32_16x16x32_bf16 v[192:195], a[232:235], a[216:219], v[192:195]
    ds_read_b128 a[60:63], v207 offset:45056
    s_add_u32 m0, s22, 0
    v_mfma_f32_16x16x32_bf16 v[192:195], a[236:239], a[220:223], v[192:195]
    buffer_load_dwordx4 v220, s[8:11], s21 offen nt lds
    v_mfma_f32_16x16x32_bf16 v[168:171], a[0:3], a[128:131], 0
    v_exp_f32 v180, v180
    v_mfma_f32_16x16x32_bf16 v[168:171], a[4:7], a[132:135], v[168:171]
    ds_read_b128 a[240:243], v227 offset:2048
    v_mfma_f32_16x16x32_bf16 v[168:171], a[8:11], a[136:139], v[168:171]
    v_exp_f32 v181, v181
    v_mfma_f32_16x16x32_bf16 v[168:171], a[12:15], a[140:143], v[168:171]
    ds_read_b128 a[244:247], v227 offset:3072
    v_cvt_pk_bf16_f32 v254, v180, v181
    v_mfma_f32_16x16x32_bf16 v[172:175], a[16:19], a[128:131], 0
    v_exp_f32 v182, v182
    v_mfma_f32_16x16x32_bf16 v[172:175], a[20:23], a[132:135], v[172:175]
    v_exp_f32 v192, v192
    v_mfma_f32_16x16x32_bf16 v[172:175], a[24:27], a[136:139], v[172:175]
    v_exp_f32 v183, v183
    v_mfma_f32_16x16x32_bf16 v[172:175], a[28:31], a[140:143], v[172:175]
    v_cvt_pk_bf16_f32 v255, v182, v183
    v_mfma_f32_16x16x32_bf16 v[176:179], a[32:35], a[128:131], 0
    s_waitcnt lgkmcnt(1)
    v_exp_f32 v168, v168
    v_mfma_f32_16x16x32_bf16 v[176:179], a[36:39], a[132:135], v[176:179]
    v_exp_f32 v193, v193
    v_mfma_f32_16x16x32_bf16 v[176:179], a[40:43], a[136:139], v[176:179]
    v_exp_f32 v169, v169
    v_mfma_f32_16x16x32_bf16 v[176:179], a[44:47], a[140:143], v[176:179]
    v_cvt_pk_bf16_f32 v184, v168, v169
    v_cvt_pk_bf16_f32 v196, v192, v193
    v_mfma_f32_16x16x32_bf16 v[180:183], a[48:51], a[128:131], 0
    v_exp_f32 v170, v170
    v_mfma_f32_16x16x32_bf16 v[180:183], a[52:55], a[132:135], v[180:183]
    v_exp_f32 v194, v194
    v_mfma_f32_16x16x32_bf16 v[180:183], a[56:59], a[136:139], v[180:183]
    v_exp_f32 v171, v171
    v_mfma_f32_16x16x32_bf16 v[180:183], a[60:63], a[140:143], v[180:183]
    v_cvt_pk_bf16_f32 v185, v170, v171
    v_smfmac_f32_16x16x64_bf16 v[230:233], a[248:251], v[248:255], v202
    v_exp_f32 v195, v195
    v_mfma_f32_16x16x32_bf16 v[136:139], v[248:251], a[72:75], v[136:139]
    v_exp_f32 v172, v172
    v_mfma_f32_16x16x32_bf16 v[136:139], v[252:255], a[104:107], v[136:139]
    ds_read_b64_tr_b16 a[72:73], v210 offset:32768
    v_cvt_pk_bf16_f32 v197, v194, v195
    v_mfma_f32_16x16x32_bf16 v[140:143], v[252:255], a[108:111], v[140:143]
    v_exp_f32 v173, v173
    v_mfma_f32_16x16x32_bf16 v[140:143], v[248:251], a[76:79], v[140:143]
    ds_read_b64_tr_b16 a[74:75], v210 offset:36864
    v_cvt_pk_bf16_f32 v186, v172, v173
    v_mfma_f32_16x16x32_bf16 v[144:147], v[248:251], a[80:83], v[144:147]
    v_exp_f32 v174, v174
    v_mfma_f32_16x16x32_bf16 v[144:147], v[252:255], a[112:115], v[144:147]
    buffer_load_dwordx4 v221, s[8:11], s21 offen offset:1024 nt lds
    v_mfma_f32_16x16x32_bf16 v[148:151], v[252:255], a[116:119], v[148:151]
    v_exp_f32 v175, v175
    v_mfma_f32_16x16x32_bf16 v[148:151], v[248:251], a[84:87], v[148:151]
    ds_read_b64_tr_b16 a[104:105], v210 offset:40960
    v_cvt_pk_bf16_f32 v187, v174, v175
    v_mfma_f32_16x16x32_bf16 v[152:155], v[248:251], a[88:91], v[152:155]
    v_exp_f32 v176, v176
    v_mfma_f32_16x16x32_bf16 v[152:155], v[252:255], a[120:123], v[152:155]
    ds_read_b64_tr_b16 a[106:107], v210 offset:45056
    ds_read_b64_tr_b16 a[108:109], v211 offset:40960
    v_mfma_f32_16x16x32_bf16 v[156:159], v[252:255], a[124:127], v[156:159]
    v_exp_f32 v177, v177
    v_mfma_f32_16x16x32_bf16 v[156:159], v[248:251], a[92:95], v[156:159]
    ds_read_b64_tr_b16 a[110:111], v211 offset:45056
    v_cvt_pk_bf16_f32 v188, v176, v177
    v_mfma_f32_16x16x32_bf16 v[128:131], v[248:251], a[64:67], v[128:131]
    v_exp_f32 v178, v178
    v_mfma_f32_16x16x32_bf16 v[128:131], v[252:255], a[96:99], v[128:131]
    ds_read_b64_tr_b16 a[76:77], v211 offset:32768
    ds_read_b64_tr_b16 a[78:79], v211 offset:36864
    v_mfma_f32_16x16x32_bf16 v[132:135], v[252:255], a[100:103], v[132:135]
    v_exp_f32 v179, v179
    v_mfma_f32_16x16x32_bf16 v[132:135], v[248:251], a[68:71], v[132:135]
    s_waitcnt lgkmcnt(4)
    ds_read_b64_tr_b16 a[80:81], v212 offset:32768
    v_cvt_pk_bf16_f32 v189, v178, v179
    v_smfmac_f32_16x16x64_bf16 v[230:233], a[252:255], a[240:247], v202
    ds_write_b64 v226, v[196:197] offset:0
    v_mfma_f32_16x16x32_bf16 v[160:163], a[240:243], a[64:67], v[160:163]
    ds_read_b64_tr_b16 a[82:83], v212 offset:36864
    ds_read_b64_tr_b16 a[112:113], v212 offset:40960
    v_mfma_f32_16x16x32_bf16 v[160:163], a[244:247], a[96:99], v[160:163]
    ds_read_b64_tr_b16 a[114:115], v212 offset:45056
    ds_read_b64_tr_b16 a[116:117], v213 offset:40960
    v_mfma_f32_16x16x32_bf16 v[164:167], a[244:247], a[100:103], v[164:167]
    ds_read_b64_tr_b16 a[118:119], v213 offset:45056
    ds_read_b64_tr_b16 a[84:85], v213 offset:32768
    v_mfma_f32_16x16x32_bf16 v[164:167], a[240:243], a[68:71], v[164:167]
    ds_read_b64_tr_b16 a[86:87], v213 offset:36864
    ds_read_b64_tr_b16 a[88:89], v214 offset:32768
    v_mfma_f32_16x16x32_bf16 v[168:171], a[0:3], a[144:147], 0
    v_exp_f32 v180, v180
    v_mfma_f32_16x16x32_bf16 v[168:171], a[4:7], a[148:151], v[168:171]
    buffer_load_dwordx4 v222, s[8:11], s21 offen offset:2048 nt lds
    v_mfma_f32_16x16x32_bf16 v[168:171], a[8:11], a[152:155], v[168:171]
    v_exp_f32 v181, v181
    v_mfma_f32_16x16x32_bf16 v[168:171], a[12:15], a[156:159], v[168:171]
    ds_read_b64_tr_b16 a[90:91], v214 offset:36864
    v_cvt_pk_bf16_f32 v190, v180, v181
    v_mfma_f32_16x16x32_bf16 v[172:175], a[16:19], a[144:147], 0
    v_exp_f32 v182, v182
    v_mfma_f32_16x16x32_bf16 v[172:175], a[20:23], a[148:151], v[172:175]
    ds_read_b64_tr_b16 a[120:121], v214 offset:40960
    ds_read_b64_tr_b16 a[122:123], v214 offset:45056
    v_mfma_f32_16x16x32_bf16 v[172:175], a[24:27], a[152:155], v[172:175]
    v_exp_f32 v183, v183
    v_mfma_f32_16x16x32_bf16 v[172:175], a[28:31], a[156:159], v[172:175]
    ds_read_b64_tr_b16 a[124:125], v215 offset:40960
    v_cvt_pk_bf16_f32 v191, v182, v183
    v_mfma_f32_16x16x32_bf16 v[176:179], a[32:35], a[144:147], 0
    v_exp_f32 v168, v168
    v_mfma_f32_16x16x32_bf16 v[176:179], a[36:39], a[148:151], v[176:179]
    ds_read_b64_tr_b16 a[126:127], v215 offset:45056
    ds_read_b64_tr_b16 a[92:93], v215 offset:32768
    v_mfma_f32_16x16x32_bf16 v[176:179], a[40:43], a[152:155], v[176:179]
    v_exp_f32 v169, v169
    v_mfma_f32_16x16x32_bf16 v[176:179], a[44:47], a[156:159], v[176:179]
    ds_read_b64_tr_b16 a[94:95], v215 offset:36864
    v_cvt_pk_bf16_f32 v248, v168, v169
    v_mfma_f32_16x16x32_bf16 v[180:183], a[48:51], a[144:147], 0
    v_exp_f32 v170, v170
    v_mfma_f32_16x16x32_bf16 v[180:183], a[52:55], a[148:151], v[180:183]
    ds_read_b64_tr_b16 a[64:65], v208 offset:32768
    ds_read_b64_tr_b16 a[66:67], v208 offset:36864
    v_mfma_f32_16x16x32_bf16 v[180:183], a[56:59], a[152:155], v[180:183]
    v_exp_f32 v171, v171
    v_mfma_f32_16x16x32_bf16 v[180:183], a[60:63], a[156:159], v[180:183]
    ds_read_b64_tr_b16 a[96:97], v208 offset:40960
    v_cvt_pk_bf16_f32 v249, v170, v171
    v_smfmac_f32_16x16x64_bf16 v[234:237], a[248:251], v[184:191], v202
    ds_read_b64_tr_b16 a[98:99], v208 offset:45056
    ds_read_b64_tr_b16 a[100:101], v209 offset:40960
    v_mfma_f32_16x16x32_bf16 v[8:11], v[184:187], a[72:75], v[8:11]
    v_exp_f32 v172, v172
    v_mfma_f32_16x16x32_bf16 v[8:11], v[188:191], a[104:107], v[8:11]
    s_waitcnt lgkmcnt(5)
    ds_read_b64_tr_b16 a[102:103], v209 offset:45056
    ds_read_b64_tr_b16 a[68:69], v209 offset:32768
    v_mfma_f32_16x16x32_bf16 v[12:15], v[188:191], a[108:111], v[12:15]
    v_exp_f32 v173, v173
    v_mfma_f32_16x16x32_bf16 v[12:15], v[184:187], a[76:79], v[12:15]
    ds_read_b64_tr_b16 a[70:71], v209 offset:36864
    v_cvt_pk_bf16_f32 v250, v172, v173
    v_mfma_f32_16x16x32_bf16 v[16:19], v[184:187], a[80:83], v[16:19]
    v_exp_f32 v174, v174
    v_mfma_f32_16x16x32_bf16 v[16:19], v[188:191], a[112:115], v[16:19]
    buffer_load_dwordx4 v223, s[8:11], s21 offen offset:3072 nt lds
    v_mfma_f32_16x16x32_bf16 v[20:23], v[188:191], a[116:119], v[20:23]
    v_exp_f32 v175, v175
    v_mfma_f32_16x16x32_bf16 v[20:23], v[184:187], a[84:87], v[20:23]
    v_cvt_pk_bf16_f32 v251, v174, v175
    v_mfma_f32_16x16x32_bf16 v[24:27], v[184:187], a[88:91], v[24:27]
    v_exp_f32 v176, v176
    s_add_u32 m0, s22, 65536
    v_mfma_f32_16x16x32_bf16 v[24:27], v[188:191], a[120:123], v[24:27]
    buffer_load_dwordx4 v224, s[12:15], s21 offen nt lds
    v_mfma_f32_16x16x32_bf16 v[28:31], v[188:191], a[124:127], v[28:31]
    v_exp_f32 v177, v177
    v_mfma_f32_16x16x32_bf16 v[28:31], v[184:187], a[92:95], v[28:31]
    s_waitcnt lgkmcnt(0)
    v_cvt_pk_bf16_f32 v252, v176, v177
    v_mfma_f32_16x16x32_bf16 v[0:3], v[184:187], a[64:67], v[0:3]
    v_exp_f32 v178, v178
    v_mfma_f32_16x16x32_bf16 v[0:3], v[188:191], a[96:99], v[0:3]
    v_mfma_f32_16x16x32_bf16 v[4:7], v[188:191], a[100:103], v[4:7]
    v_exp_f32 v179, v179
    v_mfma_f32_16x16x32_bf16 v[4:7], v[184:187], a[68:71], v[4:7]
    v_cvt_pk_bf16_f32 v253, v178, v179
    v_mfma_f32_16x16x32_bf16 v[168:171], a[0:3], a[160:163], 0
    v_exp_f32 v180, v180
    v_mfma_f32_16x16x32_bf16 v[168:171], a[4:7], a[164:167], v[168:171]
    v_mfma_f32_16x16x32_bf16 v[168:171], a[8:11], a[168:171], v[168:171]
    v_exp_f32 v181, v181
    v_mfma_f32_16x16x32_bf16 v[168:171], a[12:15], a[172:175], v[168:171]
    v_cvt_pk_bf16_f32 v254, v180, v181
    v_mfma_f32_16x16x32_bf16 v[172:175], a[16:19], a[160:163], 0
    v_exp_f32 v182, v182
    v_mfma_f32_16x16x32_bf16 v[172:175], a[20:23], a[164:167], v[172:175]
    v_mfma_f32_16x16x32_bf16 v[172:175], a[24:27], a[168:171], v[172:175]
    v_exp_f32 v183, v183
    v_mfma_f32_16x16x32_bf16 v[172:175], a[28:31], a[172:175], v[172:175]
    v_cvt_pk_bf16_f32 v255, v182, v183
    v_mfma_f32_16x16x32_bf16 v[176:179], a[32:35], a[160:163], 0
    v_exp_f32 v168, v168
    v_mfma_f32_16x16x32_bf16 v[176:179], a[36:39], a[164:167], v[176:179]
    buffer_load_dwordx4 v225, s[12:15], s21 offen offset:1024 nt lds
    v_mfma_f32_16x16x32_bf16 v[176:179], a[40:43], a[168:171], v[176:179]
    v_exp_f32 v169, v169
    v_mfma_f32_16x16x32_bf16 v[176:179], a[44:47], a[172:175], v[176:179]
    v_cvt_pk_bf16_f32 v184, v168, v169
    v_mfma_f32_16x16x32_bf16 v[180:183], a[48:51], a[160:163], 0
    v_exp_f32 v170, v170
    v_mfma_f32_16x16x32_bf16 v[180:183], a[52:55], a[164:167], v[180:183]
    v_mfma_f32_16x16x32_bf16 v[180:183], a[56:59], a[168:171], v[180:183]
    v_exp_f32 v171, v171
    v_mfma_f32_16x16x32_bf16 v[180:183], a[60:63], a[172:175], v[180:183]
    v_cvt_pk_bf16_f32 v185, v170, v171
    v_smfmac_f32_16x16x64_bf16 v[234:237], a[252:255], v[248:255], v202
    v_mfma_f32_16x16x32_bf16 v[40:43], v[248:251], a[72:75], v[40:43]
    v_exp_f32 v172, v172
    v_mfma_f32_16x16x32_bf16 v[40:43], v[252:255], a[104:107], v[40:43]
    v_mfma_f32_16x16x32_bf16 v[44:47], v[252:255], a[108:111], v[44:47]
    v_exp_f32 v173, v173
    v_mfma_f32_16x16x32_bf16 v[44:47], v[248:251], a[76:79], v[44:47]
    v_cvt_pk_bf16_f32 v186, v172, v173
    v_mfma_f32_16x16x32_bf16 v[48:51], v[248:251], a[80:83], v[48:51]
    v_exp_f32 v174, v174
    v_mfma_f32_16x16x32_bf16 v[48:51], v[252:255], a[112:115], v[48:51]
    v_mfma_f32_16x16x32_bf16 v[52:55], v[252:255], a[116:119], v[52:55]
    v_exp_f32 v175, v175
    v_mfma_f32_16x16x32_bf16 v[52:55], v[248:251], a[84:87], v[52:55]
    v_cvt_pk_bf16_f32 v187, v174, v175
    v_mfma_f32_16x16x32_bf16 v[56:59], v[248:251], a[88:91], v[56:59]
    v_exp_f32 v176, v176
    v_mfma_f32_16x16x32_bf16 v[56:59], v[252:255], a[120:123], v[56:59]
    buffer_load_dwordx4 v224, s[12:15], s21 offen offset:2048 nt lds
    v_mfma_f32_16x16x32_bf16 v[60:63], v[252:255], a[124:127], v[60:63]
    v_exp_f32 v177, v177
    v_mfma_f32_16x16x32_bf16 v[60:63], v[248:251], a[92:95], v[60:63]
    v_cvt_pk_bf16_f32 v188, v176, v177
    v_mfma_f32_16x16x32_bf16 v[32:35], v[248:251], a[64:67], v[32:35]
    v_exp_f32 v178, v178
    v_mfma_f32_16x16x32_bf16 v[32:35], v[252:255], a[96:99], v[32:35]
    v_mfma_f32_16x16x32_bf16 v[36:39], v[252:255], a[100:103], v[36:39]
    v_exp_f32 v179, v179
    v_mfma_f32_16x16x32_bf16 v[36:39], v[248:251], a[68:71], v[36:39]
    v_cvt_pk_bf16_f32 v189, v178, v179
    v_mfma_f32_16x16x32_bf16 v[168:171], a[0:3], a[176:179], 0
    v_exp_f32 v180, v180
    v_mfma_f32_16x16x32_bf16 v[168:171], a[4:7], a[180:183], v[168:171]
    v_mfma_f32_16x16x32_bf16 v[168:171], a[8:11], a[184:187], v[168:171]
    v_exp_f32 v181, v181
    v_mfma_f32_16x16x32_bf16 v[168:171], a[12:15], a[188:191], v[168:171]
    v_cvt_pk_bf16_f32 v190, v180, v181
    v_mfma_f32_16x16x32_bf16 v[172:175], a[16:19], a[176:179], 0
    v_exp_f32 v182, v182
    v_mfma_f32_16x16x32_bf16 v[172:175], a[20:23], a[180:183], v[172:175]
    v_mfma_f32_16x16x32_bf16 v[172:175], a[24:27], a[184:187], v[172:175]
    v_exp_f32 v183, v183
    v_mfma_f32_16x16x32_bf16 v[172:175], a[28:31], a[188:191], v[172:175]
    v_cvt_pk_bf16_f32 v191, v182, v183
    v_mfma_f32_16x16x32_bf16 v[176:179], a[32:35], a[176:179], 0
    v_exp_f32 v168, v168
    v_mfma_f32_16x16x32_bf16 v[176:179], a[36:39], a[180:183], v[176:179]
    buffer_load_dwordx4 v225, s[12:15], s21 offen offset:3072 nt lds
    v_mfma_f32_16x16x32_bf16 v[176:179], a[40:43], a[184:187], v[176:179]
    v_exp_f32 v169, v169
    v_mfma_f32_16x16x32_bf16 v[176:179], a[44:47], a[188:191], v[176:179]
    v_cvt_pk_bf16_f32 v248, v168, v169
    v_mfma_f32_16x16x32_bf16 v[180:183], a[48:51], a[176:179], 0
    v_exp_f32 v170, v170
    v_mfma_f32_16x16x32_bf16 v[180:183], a[52:55], a[180:183], v[180:183]
    v_mfma_f32_16x16x32_bf16 v[180:183], a[56:59], a[184:187], v[180:183]
    v_exp_f32 v171, v171
    v_mfma_f32_16x16x32_bf16 v[180:183], a[60:63], a[188:191], v[180:183]
    v_cvt_pk_bf16_f32 v249, v170, v171
    v_smfmac_f32_16x16x64_bf16 v[238:241], a[248:251], v[184:191], v202
    v_mfma_f32_16x16x32_bf16 v[72:75], v[184:187], a[72:75], v[72:75]
    v_exp_f32 v172, v172
    v_mfma_f32_16x16x32_bf16 v[72:75], v[188:191], a[104:107], v[72:75]
    v_mfma_f32_16x16x32_bf16 v[76:79], v[188:191], a[108:111], v[76:79]
    v_exp_f32 v173, v173
    v_mfma_f32_16x16x32_bf16 v[76:79], v[184:187], a[76:79], v[76:79]
    v_cvt_pk_bf16_f32 v250, v172, v173
    v_mfma_f32_16x16x32_bf16 v[80:83], v[184:187], a[80:83], v[80:83]
    v_exp_f32 v174, v174
    v_mfma_f32_16x16x32_bf16 v[80:83], v[188:191], a[112:115], v[80:83]
    v_mfma_f32_16x16x32_bf16 v[84:87], v[188:191], a[116:119], v[84:87]
    v_exp_f32 v175, v175
    v_mfma_f32_16x16x32_bf16 v[84:87], v[184:187], a[84:87], v[84:87]
    v_cvt_pk_bf16_f32 v251, v174, v175
    v_mfma_f32_16x16x32_bf16 v[88:91], v[184:187], a[88:91], v[88:91]
    v_exp_f32 v176, v176
    v_mfma_f32_16x16x32_bf16 v[88:91], v[188:191], a[120:123], v[88:91]
    v_mfma_f32_16x16x32_bf16 v[92:95], v[188:191], a[124:127], v[92:95]
    v_exp_f32 v177, v177
    v_mfma_f32_16x16x32_bf16 v[92:95], v[184:187], a[92:95], v[92:95]
    v_cvt_pk_bf16_f32 v252, v176, v177
    v_mfma_f32_16x16x32_bf16 v[64:67], v[184:187], a[64:67], v[64:67]
    v_exp_f32 v178, v178
    v_mfma_f32_16x16x32_bf16 v[64:67], v[188:191], a[96:99], v[64:67]
    v_mfma_f32_16x16x32_bf16 v[68:71], v[188:191], a[100:103], v[68:71]
    v_exp_f32 v179, v179
    v_mfma_f32_16x16x32_bf16 v[68:71], v[184:187], a[68:71], v[68:71]
    v_cvt_pk_bf16_f32 v253, v178, v179
    s_add_u32 s21, s21, 16384
    s_waitcnt vmcnt(8) lgkmcnt(15)
    s_barrier
    s_sub_u32 s23, s23, 1
    s_cmp_lt_i32 s23, 1
    s_cbranch_scc1 L_tail
    s_branch L_loop
L_tail:
    s_lshl_b32 s30, s20, 8
    v_add_u32 v225, s30, v243
    v_mfma_f32_16x16x32_bf16 v[168:171], a[0:3], a[192:195], 0
    v_exp_f32 v180, v180
    v_mfma_f32_16x16x32_bf16 v[168:171], a[4:7], a[196:199], v[168:171]
    ds_read_b128 a[224:227], v216 offset:49152
    v_mfma_f32_16x16x32_bf16 v[168:171], a[8:11], a[200:203], v[168:171]
    v_exp_f32 v181, v181
    v_mfma_f32_16x16x32_bf16 v[168:171], a[12:15], a[204:207], v[168:171]
    ds_read_b128 a[228:231], v217 offset:49152
    v_cvt_pk_bf16_f32 v254, v180, v181
    v_mfma_f32_16x16x32_bf16 v[172:175], a[16:19], a[192:195], 0
    v_exp_f32 v182, v182
    v_mfma_f32_16x16x32_bf16 v[172:175], a[20:23], a[196:199], v[172:175]
    ds_read_b128 a[232:235], v218 offset:49152
    v_mfma_f32_16x16x32_bf16 v[172:175], a[24:27], a[200:203], v[172:175]
    v_exp_f32 v183, v183
    v_mfma_f32_16x16x32_bf16 v[172:175], a[28:31], a[204:207], v[172:175]
    ds_read_b128 a[236:239], v219 offset:49152
    v_cvt_pk_bf16_f32 v255, v182, v183
    v_mfma_f32_16x16x32_bf16 v[176:179], a[32:35], a[192:195], 0
    v_exp_f32 v168, v168
    v_mfma_f32_16x16x32_bf16 v[176:179], a[36:39], a[196:199], v[176:179]
    ds_read_b128 a[0:3], v204 offset:49152
    v_mfma_f32_16x16x32_bf16 v[176:179], a[40:43], a[200:203], v[176:179]
    v_exp_f32 v169, v169
    v_mfma_f32_16x16x32_bf16 v[176:179], a[44:47], a[204:207], v[176:179]
    ds_read_b128 a[4:7], v205 offset:49152
    v_cvt_pk_bf16_f32 v184, v168, v169
    v_mfma_f32_16x16x32_bf16 v[180:183], a[48:51], a[192:195], 0
    v_exp_f32 v170, v170
    v_mfma_f32_16x16x32_bf16 v[180:183], a[52:55], a[196:199], v[180:183]
    ds_read_b128 a[8:11], v206 offset:49152
    v_mfma_f32_16x16x32_bf16 v[180:183], a[56:59], a[200:203], v[180:183]
    v_exp_f32 v171, v171
    v_mfma_f32_16x16x32_bf16 v[180:183], a[60:63], a[204:207], v[180:183]
    ds_read_b128 a[12:15], v207 offset:49152
    v_cvt_pk_bf16_f32 v185, v170, v171
    v_smfmac_f32_16x16x64_bf16 v[238:241], a[252:255], v[248:255], v202
    ds_read_b128 a[16:19], v204 offset:53248
    v_mfma_f32_16x16x32_bf16 v[104:107], v[248:251], a[72:75], v[104:107]
    v_exp_f32 v172, v172
    v_mfma_f32_16x16x32_bf16 v[104:107], v[252:255], a[104:107], v[104:107]
    ds_read_b128 a[20:23], v205 offset:53248
    v_mfma_f32_16x16x32_bf16 v[108:111], v[252:255], a[108:111], v[108:111]
    v_exp_f32 v173, v173
    v_mfma_f32_16x16x32_bf16 v[108:111], v[248:251], a[76:79], v[108:111]
    ds_read_b128 a[24:27], v206 offset:53248
    v_cvt_pk_bf16_f32 v186, v172, v173
    v_mfma_f32_16x16x32_bf16 v[112:115], v[248:251], a[80:83], v[112:115]
    v_exp_f32 v174, v174
    v_mfma_f32_16x16x32_bf16 v[112:115], v[252:255], a[112:115], v[112:115]
    ds_read_b128 a[28:31], v207 offset:53248
    v_mfma_f32_16x16x32_bf16 v[116:119], v[252:255], a[116:119], v[116:119]
    v_exp_f32 v175, v175
    v_mfma_f32_16x16x32_bf16 v[116:119], v[248:251], a[84:87], v[116:119]
    ds_read_b128 a[32:35], v204 offset:57344
    v_cvt_pk_bf16_f32 v187, v174, v175
    v_mfma_f32_16x16x32_bf16 v[120:123], v[248:251], a[88:91], v[120:123]
    v_exp_f32 v176, v176
    v_mfma_f32_16x16x32_bf16 v[120:123], v[252:255], a[120:123], v[120:123]
    ds_read_b128 a[36:39], v205 offset:57344
    v_mfma_f32_16x16x32_bf16 v[124:127], v[252:255], a[124:127], v[124:127]
    v_exp_f32 v177, v177
    v_mfma_f32_16x16x32_bf16 v[124:127], v[248:251], a[92:95], v[124:127]
    ds_read_b128 a[40:43], v206 offset:57344
    v_cvt_pk_bf16_f32 v188, v176, v177
    v_mfma_f32_16x16x32_bf16 v[96:99], v[248:251], a[64:67], v[96:99]
    v_exp_f32 v178, v178
    v_mfma_f32_16x16x32_bf16 v[96:99], v[252:255], a[96:99], v[96:99]
    ds_read_b128 a[44:47], v207 offset:57344
    v_mfma_f32_16x16x32_bf16 v[100:103], v[252:255], a[100:103], v[100:103]
    v_exp_f32 v179, v179
    v_mfma_f32_16x16x32_bf16 v[100:103], v[248:251], a[68:71], v[100:103]
    s_waitcnt lgkmcnt(3)
    ds_read_b128 a[48:51], v204 offset:61440
    v_cvt_pk_bf16_f32 v189, v178, v179
    v_mfma_f32_16x16x32_bf16 v[192:195], a[224:227], a[208:211], 0
    ds_read_b128 a[52:55], v205 offset:61440
    v_mfma_f32_16x16x32_bf16 v[192:195], a[228:231], a[212:215], v[192:195]
    ds_read_b128 a[56:59], v206 offset:61440
    v_mfma_f32_16x16x32_bf16 v[192:195], a[232:235], a[216:219], v[192:195]
    ds_read_b128 a[60:63], v207 offset:61440
    v_mfma_f32_16x16x32_bf16 v[192:195], a[236:239], a[220:223], v[192:195]
    ds_read_b128 a[240:243], v227 offset:0
    v_mfma_f32_16x16x32_bf16 v[168:171], a[0:3], a[128:131], 0
    v_exp_f32 v180, v180
    v_mfma_f32_16x16x32_bf16 v[168:171], a[4:7], a[132:135], v[168:171]
    ds_read_b128 a[244:247], v227 offset:1024
    v_mfma_f32_16x16x32_bf16 v[168:171], a[8:11], a[136:139], v[168:171]
    v_exp_f32 v181, v181
    v_mfma_f32_16x16x32_bf16 v[168:171], a[12:15], a[140:143], v[168:171]
    v_cvt_pk_bf16_f32 v190, v180, v181
    v_accvgpr_write_b32 a224, 0
    v_mfma_f32_16x16x32_bf16 v[172:175], a[16:19], a[128:131], 0
    v_exp_f32 v182, v182
    v_mfma_f32_16x16x32_bf16 v[172:175], a[20:23], a[132:135], v[172:175]
    v_accvgpr_write_b32 a225, 0
    v_accvgpr_write_b32 a226, 0
    v_mfma_f32_16x16x32_bf16 v[172:175], a[24:27], a[136:139], v[172:175]
    v_exp_f32 v183, v183
    v_mfma_f32_16x16x32_bf16 v[172:175], a[28:31], a[140:143], v[172:175]
    v_cvt_pk_bf16_f32 v191, v182, v183
    v_accvgpr_write_b32 a227, 0
    v_mfma_f32_16x16x32_bf16 v[176:179], a[32:35], a[128:131], 0
    s_waitcnt lgkmcnt(0)
    v_exp_f32 v168, v168
    v_mfma_f32_16x16x32_bf16 v[176:179], a[36:39], a[132:135], v[176:179]
    v_exp_f32 v192, v192
    v_mfma_f32_16x16x32_bf16 v[176:179], a[40:43], a[136:139], v[176:179]
    v_exp_f32 v169, v169
    v_mfma_f32_16x16x32_bf16 v[176:179], a[44:47], a[140:143], v[176:179]
    v_cvt_pk_bf16_f32 v248, v168, v169
    v_mfma_f32_16x16x32_bf16 v[180:183], a[48:51], a[128:131], 0
    v_exp_f32 v170, v170
    v_mfma_f32_16x16x32_bf16 v[180:183], a[52:55], a[132:135], v[180:183]
    v_exp_f32 v193, v193
    v_mfma_f32_16x16x32_bf16 v[180:183], a[56:59], a[136:139], v[180:183]
    v_exp_f32 v171, v171
    v_mfma_f32_16x16x32_bf16 v[180:183], a[60:63], a[140:143], v[180:183]
    v_cvt_pk_bf16_f32 v249, v170, v171
    v_cvt_pk_bf16_f32 v196, v192, v193
    v_smfmac_f32_16x16x64_bf16 v[230:233], a[248:251], v[184:191], v202
    v_exp_f32 v194, v194
    v_mfma_f32_16x16x32_bf16 v[136:139], v[184:187], a[72:75], v[136:139]
    v_exp_f32 v172, v172
    v_mfma_f32_16x16x32_bf16 v[136:139], v[188:191], a[104:107], v[136:139]
    ds_read_b64_tr_b16 a[72:73], v210 offset:49152
    ds_read_b64_tr_b16 a[74:75], v210 offset:53248
    v_mfma_f32_16x16x32_bf16 v[140:143], v[188:191], a[108:111], v[140:143]
    v_exp_f32 v173, v173
    v_mfma_f32_16x16x32_bf16 v[140:143], v[184:187], a[76:79], v[140:143]
    ds_read_b64_tr_b16 a[104:105], v210 offset:57344
    v_cvt_pk_bf16_f32 v250, v172, v173
    v_mfma_f32_16x16x32_bf16 v[144:147], v[184:187], a[80:83], v[144:147]
    v_exp_f32 v174, v174
    v_mfma_f32_16x16x32_bf16 v[144:147], v[188:191], a[112:115], v[144:147]
    ds_read_b64_tr_b16 a[80:81], v212 offset:49152
    ds_read_b64_tr_b16 a[82:83], v212 offset:53248
    v_mfma_f32_16x16x32_bf16 v[148:151], v[188:191], a[116:119], v[148:151]
    v_exp_f32 v175, v175
    v_mfma_f32_16x16x32_bf16 v[148:151], v[184:187], a[84:87], v[148:151]
    ds_read_b64_tr_b16 a[112:113], v212 offset:57344
    v_cvt_pk_bf16_f32 v251, v174, v175
    v_mfma_f32_16x16x32_bf16 v[152:155], v[184:187], a[88:91], v[152:155]
    v_exp_f32 v176, v176
    v_mfma_f32_16x16x32_bf16 v[152:155], v[188:191], a[120:123], v[152:155]
    ds_read_b64_tr_b16 a[114:115], v212 offset:61440
    ds_read_b64_tr_b16 a[116:117], v213 offset:57344
    v_mfma_f32_16x16x32_bf16 v[156:159], v[188:191], a[124:127], v[156:159]
    v_exp_f32 v177, v177
    v_mfma_f32_16x16x32_bf16 v[156:159], v[184:187], a[92:95], v[156:159]
    ds_read_b64_tr_b16 a[118:119], v213 offset:61440
    v_cvt_pk_bf16_f32 v252, v176, v177
    v_mfma_f32_16x16x32_bf16 v[128:131], v[184:187], a[64:67], v[128:131]
    v_exp_f32 v178, v178
    v_mfma_f32_16x16x32_bf16 v[128:131], v[188:191], a[96:99], v[128:131]
    ds_read_b64_tr_b16 a[84:85], v213 offset:49152
    ds_read_b64_tr_b16 a[86:87], v213 offset:53248
    v_mfma_f32_16x16x32_bf16 v[132:135], v[188:191], a[100:103], v[132:135]
    v_exp_f32 v179, v179
    v_mfma_f32_16x16x32_bf16 v[132:135], v[184:187], a[68:71], v[132:135]
    ds_read_b64_tr_b16 a[88:89], v214 offset:49152
    v_cvt_pk_bf16_f32 v253, v178, v179
    v_smfmac_f32_16x16x64_bf16 v[230:233], a[252:255], a[240:247], v202
    ds_read_b64_tr_b16 a[90:91], v214 offset:53248
    ds_read_b64_tr_b16 a[120:121], v214 offset:57344
    v_mfma_f32_16x16x32_bf16 v[160:163], a[240:243], a[64:67], v[160:163]
    ds_read_b64_tr_b16 a[122:123], v214 offset:61440
    ds_read_b64_tr_b16 a[124:125], v215 offset:57344
    v_mfma_f32_16x16x32_bf16 v[160:163], a[244:247], a[96:99], v[160:163]
    ds_read_b64_tr_b16 a[126:127], v215 offset:61440
    ds_read_b64_tr_b16 a[92:93], v215 offset:49152
    v_mfma_f32_16x16x32_bf16 v[164:167], a[244:247], a[100:103], v[164:167]
    ds_read_b64_tr_b16 a[94:95], v215 offset:53248
    ds_read_b64_tr_b16 a[106:107], v210 offset:61440
    v_mfma_f32_16x16x32_bf16 v[164:167], a[240:243], a[68:71], v[164:167]
    v_exp_f32 v195, v195
    v_mfma_f32_16x16x32_bf16 v[168:171], a[0:3], a[144:147], 0
    v_exp_f32 v180, v180
    v_mfma_f32_16x16x32_bf16 v[168:171], a[4:7], a[148:151], v[168:171]
    ds_read_b64_tr_b16 a[108:109], v211 offset:57344
    ds_read_b64_tr_b16 a[110:111], v211 offset:61440
    v_mfma_f32_16x16x32_bf16 v[168:171], a[8:11], a[152:155], v[168:171]
    v_exp_f32 v181, v181
    v_mfma_f32_16x16x32_bf16 v[168:171], a[12:15], a[156:159], v[168:171]
    ds_read_b64_tr_b16 a[76:77], v211 offset:49152
    v_cvt_pk_bf16_f32 v254, v180, v181
    v_mfma_f32_16x16x32_bf16 v[172:175], a[16:19], a[144:147], 0
    v_exp_f32 v182, v182
    v_mfma_f32_16x16x32_bf16 v[172:175], a[20:23], a[148:151], v[172:175]
    ds_read_b64_tr_b16 a[78:79], v211 offset:53248
    v_cvt_pk_bf16_f32 v197, v194, v195
    v_mfma_f32_16x16x32_bf16 v[172:175], a[24:27], a[152:155], v[172:175]
    v_exp_f32 v183, v183
    v_mfma_f32_16x16x32_bf16 v[172:175], a[28:31], a[156:159], v[172:175]
    ds_read_b64_tr_b16 a[64:65], v208 offset:49152
    v_cvt_pk_bf16_f32 v255, v182, v183
    v_mfma_f32_16x16x32_bf16 v[176:179], a[32:35], a[144:147], 0
    v_exp_f32 v168, v168
    v_mfma_f32_16x16x32_bf16 v[176:179], a[36:39], a[148:151], v[176:179]
    ds_read_b64_tr_b16 a[66:67], v208 offset:53248
    ds_read_b64_tr_b16 a[96:97], v208 offset:57344
    v_mfma_f32_16x16x32_bf16 v[176:179], a[40:43], a[152:155], v[176:179]
    v_exp_f32 v169, v169
    v_mfma_f32_16x16x32_bf16 v[176:179], a[44:47], a[156:159], v[176:179]
    ds_read_b64_tr_b16 a[98:99], v208 offset:61440
    v_cvt_pk_bf16_f32 v184, v168, v169
    v_mfma_f32_16x16x32_bf16 v[180:183], a[48:51], a[144:147], 0
    v_exp_f32 v170, v170
    v_mfma_f32_16x16x32_bf16 v[180:183], a[52:55], a[148:151], v[180:183]
    ds_write_b64 v226, v[196:197] offset:2048
    v_mfma_f32_16x16x32_bf16 v[180:183], a[56:59], a[152:155], v[180:183]
    v_exp_f32 v171, v171
    v_mfma_f32_16x16x32_bf16 v[180:183], a[60:63], a[156:159], v[180:183]
    ds_read_b64_tr_b16 a[100:101], v209 offset:57344
    v_cvt_pk_bf16_f32 v185, v170, v171
    v_smfmac_f32_16x16x64_bf16 v[234:237], a[248:251], v[248:255], v202
    s_waitcnt lgkmcnt(3)
    ds_read_b64_tr_b16 a[102:103], v209 offset:61440
    ds_read_b64_tr_b16 a[68:69], v209 offset:49152
    v_mfma_f32_16x16x32_bf16 v[16:19], v[248:251], a[80:83], v[16:19]
    v_exp_f32 v172, v172
    v_mfma_f32_16x16x32_bf16 v[16:19], v[252:255], a[112:115], v[16:19]
    ds_read_b64_tr_b16 a[70:71], v209 offset:53248
    v_mfma_f32_16x16x32_bf16 v[20:23], v[252:255], a[116:119], v[20:23]
    v_exp_f32 v173, v173
    s_waitcnt vmcnt(0) lgkmcnt(4)
    s_barrier
    v_mfma_f32_16x16x32_bf16 v[20:23], v[248:251], a[84:87], v[20:23]
    ds_read_b128 a[240:243], v227 offset:2048
    v_cvt_pk_bf16_f32 v186, v172, v173
    v_mfma_f32_16x16x32_bf16 v[24:27], v[248:251], a[88:91], v[24:27]
    ds_read_b128 a[244:247], v227 offset:3072
    v_exp_f32 v174, v174
    v_add_f32 v220, v234, v235
    v_mfma_f32_16x16x32_bf16 v[24:27], v[252:255], a[120:123], v[24:27]
    v_min_f32 v199, v220, v220
    v_max_f32 v200, v220, v220
    v_mfma_f32_16x16x32_bf16 v[28:31], v[252:255], a[124:127], v[28:31]
    v_exp_f32 v175, v175
    v_rcp_f32 v220, v220
    v_mfma_f32_16x16x32_bf16 v[28:31], v[248:251], a[92:95], v[28:31]
    ds_write_b32 v242, v220 offset:4096
    ds_read_b128 v[220:223], v225 offset:4096
    v_cvt_pk_bf16_f32 v187, v174, v175
    v_mfma_f32_16x16x32_bf16 v[8:11], v[248:251], a[72:75], v[8:11]
    v_exp_f32 v176, v176
    v_mfma_f32_16x16x32_bf16 v[8:11], v[252:255], a[104:107], v[8:11]
    v_mfma_f32_16x16x32_bf16 v[12:15], v[252:255], a[108:111], v[12:15]
    v_exp_f32 v177, v177
    v_mfma_f32_16x16x32_bf16 v[12:15], v[248:251], a[76:79], v[12:15]
    v_cvt_pk_bf16_f32 v188, v176, v177
    v_mfma_f32_16x16x32_bf16 v[0:3], v[248:251], a[64:67], v[0:3]
    v_exp_f32 v178, v178
    v_mfma_f32_16x16x32_bf16 v[0:3], v[252:255], a[96:99], v[0:3]
    s_waitcnt lgkmcnt(2)
    v_mfma_f32_16x16x32_bf16 v[4:7], v[252:255], a[100:103], v[4:7]
    v_exp_f32 v179, v179
    v_mfma_f32_16x16x32_bf16 v[4:7], v[248:251], a[68:71], v[4:7]
    v_cvt_pk_bf16_f32 v189, v178, v179
    s_waitcnt lgkmcnt(0)
    v_pk_mul_f32 v[16:17], v[16:17], v[220:221]
    v_smfmac_f32_16x16x64_bf16 v[230:233], a[252:255], a[240:247], v202
    v_pk_mul_f32 v[18:19], v[18:19], v[222:223]
    v_pk_mul_f32 v[20:21], v[20:21], v[220:221]
    v_mfma_f32_16x16x32_bf16 v[160:163], a[240:243], a[64:67], v[160:163]
    v_pk_mul_f32 v[22:23], v[22:23], v[222:223]
    v_pk_mul_f32 v[24:25], v[24:25], v[220:221]
    v_mfma_f32_16x16x32_bf16 v[160:163], a[244:247], a[96:99], v[160:163]
    v_pk_mul_f32 v[26:27], v[26:27], v[222:223]
    v_pk_mul_f32 v[28:29], v[28:29], v[220:221]
    v_mfma_f32_16x16x32_bf16 v[164:167], a[244:247], a[100:103], v[164:167]
    v_pk_mul_f32 v[30:31], v[30:31], v[222:223]
    v_cvt_pk_bf16_f32 v16, v16, v20
    v_mfma_f32_16x16x32_bf16 v[164:167], a[240:243], a[68:71], v[164:167]
    v_add_f32 v216, v230, v231
    v_cvt_pk_bf16_f32 v20, v17, v21
    v_mfma_f32_16x16x32_bf16 v[168:171], a[0:3], a[160:163], 0
    v_exp_f32 v180, v180
    v_mfma_f32_16x16x32_bf16 v[168:171], a[4:7], a[164:167], v[168:171]
    v_min_f32 v199, v199, v216
    v_max_f32 v200, v200, v216
    v_mfma_f32_16x16x32_bf16 v[168:171], a[8:11], a[168:171], v[168:171]
    v_exp_f32 v181, v181
    v_rcp_f32 v216, v216
    v_mfma_f32_16x16x32_bf16 v[168:171], a[12:15], a[172:175], v[168:171]
    ds_write_b32 v242, v216 offset:4096
    ds_read_b128 v[216:219], v225 offset:4224
    v_cvt_pk_bf16_f32 v190, v180, v181
    v_mfma_f32_16x16x32_bf16 v[172:175], a[16:19], a[160:163], 0
    v_exp_f32 v182, v182
    v_mfma_f32_16x16x32_bf16 v[172:175], a[20:23], a[164:167], v[172:175]
    v_cvt_pk_bf16_f32 v17, v24, v28
    v_cvt_pk_bf16_f32 v21, v25, v29
    v_mfma_f32_16x16x32_bf16 v[172:175], a[24:27], a[168:171], v[172:175]
    v_exp_f32 v183, v183
    v_mfma_f32_16x16x32_bf16 v[172:175], a[28:31], a[172:175], v[172:175]
    v_cvt_pk_bf16_f32 v191, v182, v183
    v_cvt_pk_bf16_f32 v18, v18, v22
    v_mfma_f32_16x16x32_bf16 v[176:179], a[32:35], a[160:163], 0
    ds_write_b64 v244, v[16:17] offset:128
    ds_write_b64 v244, v[20:21] offset:416
    v_exp_f32 v168, v168
    v_mfma_f32_16x16x32_bf16 v[176:179], a[36:39], a[164:167], v[176:179]
    v_cvt_pk_bf16_f32 v22, v19, v23
    v_cvt_pk_bf16_f32 v19, v26, v30
    v_cvt_pk_bf16_f32 v23, v27, v31
    v_mfma_f32_16x16x32_bf16 v[176:179], a[40:43], a[168:171], v[176:179]
    ds_write_b64 v244, v[18:19] offset:768
    ds_write_b64 v244, v[22:23] offset:1056
    v_exp_f32 v169, v169
    s_waitcnt lgkmcnt(4)
    v_pk_mul_f32 v[160:161], v[160:161], v[216:217]
    v_pk_mul_f32 v[162:163], v[162:163], v[218:219]
    v_pk_mul_f32 v[164:165], v[164:165], v[216:217]
    v_pk_mul_f32 v[166:167], v[166:167], v[218:219]
    v_mfma_f32_16x16x32_bf16 v[176:179], a[44:47], a[172:175], v[176:179]
    ds_read_b64_tr_b16 v[16:17], v245 offset:128
    ds_read_b64_tr_b16 v[18:19], v245 offset:160
    ds_read_b64_tr_b16 v[20:21], v245 offset:2688
    ds_read_b64_tr_b16 v[22:23], v245 offset:2720
    v_cvt_pk_bf16_f32 v248, v168, v169
    v_cvt_pk_bf16_f32 v160, v160, v164
    v_cvt_pk_bf16_f32 v161, v161, v165
    v_cvt_pk_bf16_f32 v162, v162, v166
    v_cvt_pk_bf16_f32 v163, v163, v167
    v_pk_mul_f32 v[8:9], v[8:9], v[220:221]
    v_pk_mul_f32 v[10:11], v[10:11], v[222:223]
    v_mfma_f32_16x16x32_bf16 v[180:183], a[48:51], a[160:163], 0
    v_exp_f32 v170, v170
    v_mfma_f32_16x16x32_bf16 v[180:183], a[52:55], a[164:167], v[180:183]
    v_pk_mul_f32 v[12:13], v[12:13], v[220:221]
    v_pk_mul_f32 v[14:15], v[14:15], v[222:223]
    v_mfma_f32_16x16x32_bf16 v[180:183], a[56:59], a[168:171], v[180:183]
    v_exp_f32 v171, v171
    v_mfma_f32_16x16x32_bf16 v[180:183], a[60:63], a[172:175], v[180:183]
    v_cvt_pk_bf16_f32 v249, v170, v171
    v_pk_mul_f32 v[0:1], v[0:1], v[220:221]
    v_pk_mul_f32 v[2:3], v[2:3], v[222:223]
    v_smfmac_f32_16x16x64_bf16 v[234:237], a[252:255], v[184:191], v202
    v_pk_mul_f32 v[4:5], v[4:5], v[220:221]
    v_pk_mul_f32 v[6:7], v[6:7], v[222:223]
    v_mfma_f32_16x16x32_bf16 v[48:51], v[184:187], a[80:83], v[48:51]
    v_exp_f32 v172, v172
    v_mfma_f32_16x16x32_bf16 v[48:51], v[188:191], a[112:115], v[48:51]
    s_add_u32 s31, s29, 0
    s_waitcnt lgkmcnt(0)
    buffer_store_dwordx4 v[16:19], v247, s[16:19], s31 offen sc1 nt
    buffer_store_dwordx4 v[20:23], v247, s[16:19], s31 offen offset:2048 sc1 nt
    v_smfmac_f32_16x16x64_bf16 a[224:227], a[248:251], v[16:23], v202
    v_mfma_f32_16x16x32_bf16 v[52:55], v[188:191], a[116:119], v[52:55]
    v_exp_f32 v173, v173
    v_cvt_pk_bf16_f32 v0, v0, v4
    v_cvt_pk_bf16_f32 v4, v1, v5
    v_cvt_pk_bf16_f32 v1, v8, v12
    v_cvt_pk_bf16_f32 v5, v9, v13
    v_mfma_f32_16x16x32_bf16 v[52:55], v[184:187], a[84:87], v[52:55]
    ds_write_b64 v244, v[0:1] offset:0
    ds_write_b64 v244, v[4:5] offset:288
    v_cvt_pk_bf16_f32 v250, v172, v173
    v_mfma_f32_16x16x32_bf16 v[56:59], v[184:187], a[88:91], v[56:59]
    v_exp_f32 v174, v174
    v_cvt_pk_bf16_f32 v2, v2, v6
    v_cvt_pk_bf16_f32 v6, v3, v7
    v_cvt_pk_bf16_f32 v3, v10, v14
    v_cvt_pk_bf16_f32 v7, v11, v15
    v_add_f32 v220, v234, v235
    v_mfma_f32_16x16x32_bf16 v[56:59], v[188:191], a[120:123], v[56:59]
    ds_write_b64 v244, v[2:3] offset:640
    ds_write_b64 v244, v[6:7] offset:928
    v_min_f32 v199, v199, v220
    v_max_f32 v200, v200, v220
    v_mfma_f32_16x16x32_bf16 v[60:63], v[188:191], a[124:127], v[60:63]
    ds_read_b64_tr_b16 v[0:1], v245 offset:0
    ds_read_b64_tr_b16 v[2:3], v245 offset:32
    ds_read_b64_tr_b16 v[4:5], v245 offset:2560
    ds_read_b64_tr_b16 v[6:7], v245 offset:2592
    ds_write_b64 v198, v[160:161] offset:0
    ds_write_b64 v198, v[162:163] offset:288
    ds_read_b64_tr_b16 v[160:161], v245 offset:0
    ds_read_b64_tr_b16 v[162:163], v245 offset:32
    v_exp_f32 v175, v175
    v_rcp_f32 v220, v220
    v_mfma_f32_16x16x32_bf16 v[60:63], v[184:187], a[92:95], v[60:63]
    ds_write_b32 v242, v220 offset:4096
    ds_read_b128 v[220:223], v225 offset:4224
    v_cvt_pk_bf16_f32 v251, v174, v175
    v_mfma_f32_16x16x32_bf16 v[40:43], v[184:187], a[72:75], v[40:43]
    v_exp_f32 v176, v176
    v_mfma_f32_16x16x32_bf16 v[40:43], v[188:191], a[104:107], v[40:43]
    v_mfma_f32_16x16x32_bf16 v[44:47], v[188:191], a[108:111], v[44:47]
    v_exp_f32 v177, v177
    v_mfma_f32_16x16x32_bf16 v[44:47], v[184:187], a[76:79], v[44:47]
    v_cvt_pk_bf16_f32 v252, v176, v177
    v_mfma_f32_16x16x32_bf16 v[32:35], v[184:187], a[64:67], v[32:35]
    v_exp_f32 v178, v178
    v_mfma_f32_16x16x32_bf16 v[32:35], v[188:191], a[96:99], v[32:35]
    s_waitcnt lgkmcnt(2)
    buffer_store_dwordx4 v[160:163], v246, s[16:19], s26 offen sc1 nt
    v_mfma_f32_16x16x32_bf16 a[224:227], v[160:163], a[248:251], a[224:227]
    s_add_u32 s30, s28, 0
    buffer_store_dwordx4 v[0:3], v247, s[16:19], s30 offen sc1 nt
    buffer_store_dwordx4 v[4:7], v247, s[16:19], s30 offen offset:2048 sc1 nt
    v_smfmac_f32_16x16x64_bf16 a[224:227], a[248:251], v[0:7], v202
    v_mfma_f32_16x16x32_bf16 v[36:39], v[188:191], a[100:103], v[36:39]
    v_exp_f32 v179, v179
    v_mfma_f32_16x16x32_bf16 v[36:39], v[184:187], a[68:71], v[36:39]
    v_cvt_pk_bf16_f32 v253, v178, v179
    s_waitcnt lgkmcnt(0)
    v_pk_mul_f32 v[48:49], v[48:49], v[220:221]
    v_mfma_f32_16x16x32_bf16 v[168:171], a[0:3], a[176:179], 0
    v_exp_f32 v180, v180
    v_mfma_f32_16x16x32_bf16 v[168:171], a[4:7], a[180:183], v[168:171]
    v_pk_mul_f32 v[50:51], v[50:51], v[222:223]
    v_pk_mul_f32 v[52:53], v[52:53], v[220:221]
    v_mfma_f32_16x16x32_bf16 v[168:171], a[8:11], a[184:187], v[168:171]
    v_exp_f32 v181, v181
    v_mfma_f32_16x16x32_bf16 v[168:171], a[12:15], a[188:191], v[168:171]
    v_cvt_pk_bf16_f32 v254, v180, v181
    v_pk_mul_f32 v[54:55], v[54:55], v[222:223]
    v_mfma_f32_16x16x32_bf16 v[172:175], a[16:19], a[176:179], 0
    v_exp_f32 v182, v182
    v_mfma_f32_16x16x32_bf16 v[172:175], a[20:23], a[180:183], v[172:175]
    v_pk_mul_f32 v[56:57], v[56:57], v[220:221]
    v_pk_mul_f32 v[58:59], v[58:59], v[222:223]
    v_mfma_f32_16x16x32_bf16 v[172:175], a[24:27], a[184:187], v[172:175]
    v_exp_f32 v183, v183
    v_mfma_f32_16x16x32_bf16 v[172:175], a[28:31], a[188:191], v[172:175]
    v_cvt_pk_bf16_f32 v255, v182, v183
    v_pk_mul_f32 v[60:61], v[60:61], v[220:221]
    v_mfma_f32_16x16x32_bf16 v[176:179], a[32:35], a[176:179], 0
    v_exp_f32 v168, v168
    v_mfma_f32_16x16x32_bf16 v[176:179], a[36:39], a[180:183], v[176:179]
    v_pk_mul_f32 v[62:63], v[62:63], v[222:223]
    v_cvt_pk_bf16_f32 v48, v48, v52
    v_mfma_f32_16x16x32_bf16 v[176:179], a[40:43], a[184:187], v[176:179]
    v_exp_f32 v169, v169
    v_mfma_f32_16x16x32_bf16 v[176:179], a[44:47], a[188:191], v[176:179]
    v_cvt_pk_bf16_f32 v184, v168, v169
    v_cvt_pk_bf16_f32 v52, v49, v53
    v_mfma_f32_16x16x32_bf16 v[180:183], a[48:51], a[176:179], 0
    v_exp_f32 v170, v170
    v_cvt_pk_bf16_f32 v49, v56, v60
    v_cvt_pk_bf16_f32 v53, v57, v61
    v_mfma_f32_16x16x32_bf16 v[180:183], a[52:55], a[180:183], v[180:183]
    ds_write_b64 v244, v[48:49] offset:128
    ds_write_b64 v244, v[52:53] offset:416
    v_mfma_f32_16x16x32_bf16 v[180:183], a[56:59], a[184:187], v[180:183]
    v_exp_f32 v171, v171
    v_cvt_pk_bf16_f32 v50, v50, v54
    v_cvt_pk_bf16_f32 v54, v51, v55
    v_cvt_pk_bf16_f32 v51, v58, v62
    v_cvt_pk_bf16_f32 v55, v59, v63
    v_mfma_f32_16x16x32_bf16 v[180:183], a[60:63], a[188:191], v[180:183]
    ds_write_b64 v244, v[50:51] offset:768
    ds_write_b64 v244, v[54:55] offset:1056
    v_cvt_pk_bf16_f32 v185, v170, v171
    v_smfmac_f32_16x16x64_bf16 v[238:241], a[248:251], v[248:255], v202
    ds_read_b64_tr_b16 v[48:49], v245 offset:128
    ds_read_b64_tr_b16 v[50:51], v245 offset:160
    ds_read_b64_tr_b16 v[52:53], v245 offset:2688
    ds_read_b64_tr_b16 v[54:55], v245 offset:2720
    v_pk_mul_f32 v[40:41], v[40:41], v[220:221]
    v_pk_mul_f32 v[42:43], v[42:43], v[222:223]
    v_mfma_f32_16x16x32_bf16 v[80:83], v[248:251], a[80:83], v[80:83]
    v_exp_f32 v172, v172
    v_mfma_f32_16x16x32_bf16 v[80:83], v[252:255], a[112:115], v[80:83]
    v_pk_mul_f32 v[44:45], v[44:45], v[220:221]
    v_pk_mul_f32 v[46:47], v[46:47], v[222:223]
    v_mfma_f32_16x16x32_bf16 v[84:87], v[252:255], a[116:119], v[84:87]
    v_exp_f32 v173, v173
    v_mfma_f32_16x16x32_bf16 v[84:87], v[248:251], a[84:87], v[84:87]
    v_cvt_pk_bf16_f32 v186, v172, v173
    v_pk_mul_f32 v[32:33], v[32:33], v[220:221]
    v_pk_mul_f32 v[34:35], v[34:35], v[222:223]
    v_mfma_f32_16x16x32_bf16 v[88:91], v[248:251], a[88:91], v[88:91]
    v_exp_f32 v174, v174
    v_add_f32 v216, v238, v239
    v_mfma_f32_16x16x32_bf16 v[88:91], v[252:255], a[120:123], v[88:91]
    v_pk_mul_f32 v[36:37], v[36:37], v[220:221]
    v_pk_mul_f32 v[38:39], v[38:39], v[222:223]
    v_min_f32 v199, v199, v216
    v_max_f32 v200, v200, v216
    v_mfma_f32_16x16x32_bf16 v[92:95], v[252:255], a[124:127], v[92:95]
    s_add_u32 s35, s29, 4096
    s_waitcnt lgkmcnt(0)
    buffer_store_dwordx4 v[48:51], v247, s[16:19], s35 offen sc1 nt
    buffer_store_dwordx4 v[52:55], v247, s[16:19], s35 offen offset:2048 sc1 nt
    v_smfmac_f32_16x16x64_bf16 a[224:227], a[248:251], v[48:55], v202
    v_exp_f32 v175, v175
    v_rcp_f32 v216, v216
    v_mfma_f32_16x16x32_bf16 v[92:95], v[248:251], a[92:95], v[92:95]
    ds_write_b32 v242, v216 offset:4096
    ds_read_b128 v[216:219], v225 offset:4096
    v_cvt_pk_bf16_f32 v187, v174, v175
    v_cvt_pk_bf16_f32 v32, v32, v36
    v_cvt_pk_bf16_f32 v36, v33, v37
    v_cvt_pk_bf16_f32 v33, v40, v44
    v_cvt_pk_bf16_f32 v37, v41, v45
    v_mfma_f32_16x16x32_bf16 v[72:75], v[248:251], a[72:75], v[72:75]
    ds_write_b64 v244, v[32:33] offset:0
    ds_write_b64 v244, v[36:37] offset:288
    v_exp_f32 v176, v176
    v_mfma_f32_16x16x32_bf16 v[72:75], v[252:255], a[104:107], v[72:75]
    v_cvt_pk_bf16_f32 v34, v34, v38
    v_cvt_pk_bf16_f32 v38, v35, v39
    v_cvt_pk_bf16_f32 v35, v42, v46
    v_cvt_pk_bf16_f32 v39, v43, v47
    v_mfma_f32_16x16x32_bf16 v[76:79], v[252:255], a[108:111], v[76:79]
    ds_write_b64 v244, v[34:35] offset:640
    ds_write_b64 v244, v[38:39] offset:928
    v_exp_f32 v177, v177
    v_mfma_f32_16x16x32_bf16 v[76:79], v[248:251], a[76:79], v[76:79]
    ds_read_b64_tr_b16 v[32:33], v245 offset:0
    ds_read_b64_tr_b16 v[34:35], v245 offset:32
    ds_read_b64_tr_b16 v[36:37], v245 offset:2560
    ds_read_b64_tr_b16 v[38:39], v245 offset:2592
    v_cvt_pk_bf16_f32 v188, v176, v177
    v_mfma_f32_16x16x32_bf16 v[64:67], v[248:251], a[64:67], v[64:67]
    v_exp_f32 v178, v178
    v_mfma_f32_16x16x32_bf16 v[64:67], v[252:255], a[96:99], v[64:67]
    v_mfma_f32_16x16x32_bf16 v[68:71], v[252:255], a[100:103], v[68:71]
    v_exp_f32 v179, v179
    v_mfma_f32_16x16x32_bf16 v[68:71], v[248:251], a[68:71], v[68:71]
    v_cvt_pk_bf16_f32 v189, v178, v179
    s_waitcnt lgkmcnt(4)
    v_pk_mul_f32 v[80:81], v[80:81], v[216:217]
    v_mfma_f32_16x16x32_bf16 v[168:171], a[0:3], a[192:195], 0
    v_exp_f32 v180, v180
    v_mfma_f32_16x16x32_bf16 v[168:171], a[4:7], a[196:199], v[168:171]
    v_pk_mul_f32 v[82:83], v[82:83], v[218:219]
    v_pk_mul_f32 v[84:85], v[84:85], v[216:217]
    v_mfma_f32_16x16x32_bf16 v[168:171], a[8:11], a[200:203], v[168:171]
    s_add_u32 s34, s28, 4096
    s_waitcnt lgkmcnt(0)
    buffer_store_dwordx4 v[32:35], v247, s[16:19], s34 offen sc1 nt
    buffer_store_dwordx4 v[36:39], v247, s[16:19], s34 offen offset:2048 sc1 nt
    v_smfmac_f32_16x16x64_bf16 a[224:227], a[248:251], v[32:39], v202
    v_exp_f32 v181, v181
    v_mfma_f32_16x16x32_bf16 v[168:171], a[12:15], a[204:207], v[168:171]
    v_cvt_pk_bf16_f32 v190, v180, v181
    v_pk_mul_f32 v[86:87], v[86:87], v[218:219]
    v_mfma_f32_16x16x32_bf16 v[172:175], a[16:19], a[192:195], 0
    v_exp_f32 v182, v182
    v_mfma_f32_16x16x32_bf16 v[172:175], a[20:23], a[196:199], v[172:175]
    v_pk_mul_f32 v[88:89], v[88:89], v[216:217]
    v_pk_mul_f32 v[90:91], v[90:91], v[218:219]
    v_mfma_f32_16x16x32_bf16 v[172:175], a[24:27], a[200:203], v[172:175]
    v_exp_f32 v183, v183
    v_mfma_f32_16x16x32_bf16 v[172:175], a[28:31], a[204:207], v[172:175]
    v_cvt_pk_bf16_f32 v191, v182, v183
    v_pk_mul_f32 v[92:93], v[92:93], v[216:217]
    v_mfma_f32_16x16x32_bf16 v[176:179], a[32:35], a[192:195], 0
    v_exp_f32 v168, v168
    v_mfma_f32_16x16x32_bf16 v[176:179], a[36:39], a[196:199], v[176:179]
    v_pk_mul_f32 v[94:95], v[94:95], v[218:219]
    v_cvt_pk_bf16_f32 v80, v80, v84
    v_mfma_f32_16x16x32_bf16 v[176:179], a[40:43], a[200:203], v[176:179]
    v_exp_f32 v169, v169
    v_mfma_f32_16x16x32_bf16 v[176:179], a[44:47], a[204:207], v[176:179]
    v_cvt_pk_bf16_f32 v248, v168, v169
    v_cvt_pk_bf16_f32 v84, v81, v85
    v_mfma_f32_16x16x32_bf16 v[180:183], a[48:51], a[192:195], 0
    v_exp_f32 v170, v170
    v_cvt_pk_bf16_f32 v81, v88, v92
    v_cvt_pk_bf16_f32 v85, v89, v93
    v_mfma_f32_16x16x32_bf16 v[180:183], a[52:55], a[196:199], v[180:183]
    ds_write_b64 v244, v[80:81] offset:128
    ds_write_b64 v244, v[84:85] offset:416
    v_mfma_f32_16x16x32_bf16 v[180:183], a[56:59], a[200:203], v[180:183]
    v_exp_f32 v171, v171
    v_cvt_pk_bf16_f32 v82, v82, v86
    v_cvt_pk_bf16_f32 v86, v83, v87
    v_cvt_pk_bf16_f32 v83, v90, v94
    v_cvt_pk_bf16_f32 v87, v91, v95
    v_mfma_f32_16x16x32_bf16 v[180:183], a[60:63], a[204:207], v[180:183]
    ds_write_b64 v244, v[82:83] offset:768
    ds_write_b64 v244, v[86:87] offset:1056
    v_cvt_pk_bf16_f32 v249, v170, v171
    v_smfmac_f32_16x16x64_bf16 v[238:241], a[252:255], v[184:191], v202
    ds_read_b64_tr_b16 v[80:81], v245 offset:128
    ds_read_b64_tr_b16 v[82:83], v245 offset:160
    ds_read_b64_tr_b16 v[84:85], v245 offset:2688
    ds_read_b64_tr_b16 v[86:87], v245 offset:2720
    v_exp_f32 v172, v172
    v_pk_mul_f32 v[72:73], v[72:73], v[216:217]
    v_pk_mul_f32 v[74:75], v[74:75], v[218:219]
    v_mfma_f32_16x16x32_bf16 v[112:115], v[184:187], a[80:83], v[112:115]
    v_exp_f32 v173, v173
    v_mfma_f32_16x16x32_bf16 v[112:115], v[188:191], a[112:115], v[112:115]
    v_cvt_pk_bf16_f32 v250, v172, v173
    v_exp_f32 v174, v174
    v_pk_mul_f32 v[76:77], v[76:77], v[216:217]
    v_pk_mul_f32 v[78:79], v[78:79], v[218:219]
    v_mfma_f32_16x16x32_bf16 v[116:119], v[188:191], a[116:119], v[116:119]
    v_exp_f32 v175, v175
    v_mfma_f32_16x16x32_bf16 v[116:119], v[184:187], a[84:87], v[116:119]
    v_cvt_pk_bf16_f32 v251, v174, v175
    v_exp_f32 v176, v176
    v_pk_mul_f32 v[64:65], v[64:65], v[216:217]
    v_pk_mul_f32 v[66:67], v[66:67], v[218:219]
    v_mfma_f32_16x16x32_bf16 v[120:123], v[184:187], a[88:91], v[120:123]
    v_exp_f32 v177, v177
    v_add_f32 v220, v238, v239
    v_mfma_f32_16x16x32_bf16 v[120:123], v[188:191], a[120:123], v[120:123]
    v_cvt_pk_bf16_f32 v252, v176, v177
    v_exp_f32 v178, v178
    v_pk_mul_f32 v[68:69], v[68:69], v[216:217]
    v_pk_mul_f32 v[70:71], v[70:71], v[218:219]
    v_min_f32 v199, v199, v220
    v_max_f32 v200, v200, v220
    v_mfma_f32_16x16x32_bf16 v[124:127], v[188:191], a[124:127], v[124:127]
    s_add_u32 s31, s29, 8192
    s_waitcnt lgkmcnt(0)
    buffer_store_dwordx4 v[80:83], v247, s[16:19], s31 offen sc1 nt
    buffer_store_dwordx4 v[84:87], v247, s[16:19], s31 offen offset:2048 sc1 nt
    v_smfmac_f32_16x16x64_bf16 a[224:227], a[248:251], v[80:87], v202
    v_exp_f32 v179, v179
    v_rcp_f32 v220, v220
    v_mfma_f32_16x16x32_bf16 v[124:127], v[184:187], a[92:95], v[124:127]
    ds_write_b32 v242, v220 offset:4096
    ds_read_b128 v[220:223], v225 offset:4224
    v_cvt_pk_bf16_f32 v253, v178, v179
    v_exp_f32 v180, v180
    v_cvt_pk_bf16_f32 v64, v64, v68
    v_cvt_pk_bf16_f32 v68, v65, v69
    v_cvt_pk_bf16_f32 v65, v72, v76
    v_cvt_pk_bf16_f32 v69, v73, v77
    v_mfma_f32_16x16x32_bf16 v[104:107], v[184:187], a[72:75], v[104:107]
    ds_write_b64 v244, v[64:65] offset:0
    ds_write_b64 v244, v[68:69] offset:288
    v_exp_f32 v181, v181
    v_mfma_f32_16x16x32_bf16 v[104:107], v[188:191], a[104:107], v[104:107]
    v_cvt_pk_bf16_f32 v254, v180, v181
    v_exp_f32 v182, v182
    v_cvt_pk_bf16_f32 v66, v66, v70
    v_cvt_pk_bf16_f32 v70, v67, v71
    v_cvt_pk_bf16_f32 v67, v74, v78
    v_cvt_pk_bf16_f32 v71, v75, v79
    v_mfma_f32_16x16x32_bf16 v[108:111], v[188:191], a[108:111], v[108:111]
    ds_write_b64 v244, v[66:67] offset:640
    ds_write_b64 v244, v[70:71] offset:928
    v_exp_f32 v183, v183
    v_mfma_f32_16x16x32_bf16 v[108:111], v[184:187], a[76:79], v[108:111]
    ds_read_b64_tr_b16 v[64:65], v245 offset:0
    ds_read_b64_tr_b16 v[66:67], v245 offset:32
    ds_read_b64_tr_b16 v[68:69], v245 offset:2560
    ds_read_b64_tr_b16 v[70:71], v245 offset:2592
    v_cvt_pk_bf16_f32 v255, v182, v183
    v_mfma_f32_16x16x32_bf16 v[96:99], v[184:187], a[64:67], v[96:99]
    v_mfma_f32_16x16x32_bf16 v[96:99], v[188:191], a[96:99], v[96:99]
    v_mfma_f32_16x16x32_bf16 v[100:103], v[188:191], a[100:103], v[100:103]
    s_waitcnt lgkmcnt(6)
    v_pk_mul_f32 v[112:113], v[112:113], v[220:221]
    v_pk_mul_f32 v[114:115], v[114:115], v[222:223]
    v_mfma_f32_16x16x32_bf16 v[100:103], v[184:187], a[68:71], v[100:103]
    v_pk_mul_f32 v[116:117], v[116:117], v[220:221]
    v_pk_mul_f32 v[118:119], v[118:119], v[222:223]
    v_smfmac_f32_16x16x64_bf16 v[230:233], a[248:251], v[248:255], v202
    v_pk_mul_f32 v[120:121], v[120:121], v[220:221]
    v_pk_mul_f32 v[122:123], v[122:123], v[222:223]
    v_mfma_f32_16x16x32_bf16 v[144:147], v[248:251], a[80:83], v[144:147]
    v_pk_mul_f32 v[124:125], v[124:125], v[220:221]
    v_pk_mul_f32 v[126:127], v[126:127], v[222:223]
    v_mfma_f32_16x16x32_bf16 v[144:147], v[252:255], a[112:115], v[144:147]
    s_add_u32 s30, s28, 8192
    s_waitcnt lgkmcnt(0)
    buffer_store_dwordx4 v[64:67], v247, s[16:19], s30 offen sc1 nt
    buffer_store_dwordx4 v[68:71], v247, s[16:19], s30 offen offset:2048 sc1 nt
    v_smfmac_f32_16x16x64_bf16 a[224:227], a[248:251], v[64:71], v202
    v_mfma_f32_16x16x32_bf16 v[148:151], v[252:255], a[116:119], v[148:151]
    v_cvt_pk_bf16_f32 v112, v112, v116
    v_cvt_pk_bf16_f32 v116, v113, v117
    v_mfma_f32_16x16x32_bf16 v[148:151], v[248:251], a[84:87], v[148:151]
    v_add_f32 v216, v230, v231
    v_cvt_pk_bf16_f32 v113, v120, v124
    v_mfma_f32_16x16x32_bf16 v[152:155], v[248:251], a[88:91], v[152:155]
    v_min_f32 v199, v199, v216
    v_max_f32 v200, v200, v216
    v_mfma_f32_16x16x32_bf16 v[152:155], v[252:255], a[120:123], v[152:155]
    v_rcp_f32 v216, v216
    v_mfma_f32_16x16x32_bf16 v[156:159], v[252:255], a[124:127], v[156:159]
    ds_write_b32 v242, v216 offset:4096
    v_cvt_pk_bf16_f32 v117, v121, v125
    v_mfma_f32_16x16x32_bf16 v[156:159], v[248:251], a[92:95], v[156:159]
    ds_read_b128 v[216:219], v225 offset:4096
    v_cvt_pk_bf16_f32 v114, v114, v118
    v_mfma_f32_16x16x32_bf16 v[136:139], v[248:251], a[72:75], v[136:139]
    ds_write_b64 v244, v[112:113] offset:128
    v_mfma_f32_16x16x32_bf16 v[136:139], v[252:255], a[104:107], v[136:139]
    ds_write_b64 v244, v[116:117] offset:416
    v_mfma_f32_16x16x32_bf16 v[140:143], v[252:255], a[108:111], v[140:143]
    v_cvt_pk_bf16_f32 v118, v115, v119
    v_cvt_pk_bf16_f32 v115, v122, v126
    v_mfma_f32_16x16x32_bf16 v[140:143], v[248:251], a[76:79], v[140:143]
    v_cvt_pk_bf16_f32 v119, v123, v127
    v_pk_mul_f32 v[104:105], v[104:105], v[220:221]
    v_mfma_f32_16x16x32_bf16 v[128:131], v[248:251], a[64:67], v[128:131]
    ds_write_b64 v244, v[114:115] offset:768
    v_mfma_f32_16x16x32_bf16 v[128:131], v[252:255], a[96:99], v[128:131]
    ds_write_b64 v244, v[118:119] offset:1056
    v_mfma_f32_16x16x32_bf16 v[132:135], v[252:255], a[100:103], v[132:135]
    ds_read_b64_tr_b16 v[112:113], v245 offset:128
    ds_read_b64_tr_b16 v[114:115], v245 offset:160
    v_mfma_f32_16x16x32_bf16 v[132:135], v[248:251], a[68:71], v[132:135]
    ds_read_b64_tr_b16 v[116:117], v245 offset:2688
    ds_read_b64_tr_b16 v[118:119], v245 offset:2720
    v_pk_mul_f32 v[106:107], v[106:107], v[222:223]
    v_pk_mul_f32 v[108:109], v[108:109], v[220:221]
    v_pk_mul_f32 v[110:111], v[110:111], v[222:223]
    v_pk_mul_f32 v[96:97], v[96:97], v[220:221]
    v_pk_mul_f32 v[98:99], v[98:99], v[222:223]
    s_waitcnt lgkmcnt(6)
    v_pk_mul_f32 v[144:145], v[144:145], v[216:217]
    v_pk_mul_f32 v[146:147], v[146:147], v[218:219]
    v_pk_mul_f32 v[100:101], v[100:101], v[220:221]
    v_pk_mul_f32 v[102:103], v[102:103], v[222:223]
    v_pk_mul_f32 v[148:149], v[148:149], v[216:217]
    v_pk_mul_f32 v[150:151], v[150:151], v[218:219]
    v_cvt_pk_bf16_f32 v96, v96, v100
    v_cvt_pk_bf16_f32 v100, v97, v101
    v_cvt_pk_bf16_f32 v97, v104, v108
    v_cvt_pk_bf16_f32 v101, v105, v109
    v_pk_mul_f32 v[152:153], v[152:153], v[216:217]
    v_pk_mul_f32 v[154:155], v[154:155], v[218:219]
    ds_write_b64 v244, v[96:97] offset:0
    v_cvt_pk_bf16_f32 v98, v98, v102
    v_cvt_pk_bf16_f32 v102, v99, v103
    s_add_u32 s35, s29, 12288
    s_waitcnt lgkmcnt(1)
    buffer_store_dwordx4 v[112:115], v247, s[16:19], s35 offen sc1 nt
    ds_write_b64 v244, v[100:101] offset:288
    buffer_store_dwordx4 v[116:119], v247, s[16:19], s35 offen offset:2048 sc1 nt
    v_smfmac_f32_16x16x64_bf16 a[224:227], a[248:251], v[112:119], v202
    v_cvt_pk_bf16_f32 v99, v106, v110
    v_cvt_pk_bf16_f32 v103, v107, v111
    ds_write_b64 v244, v[98:99] offset:640
    v_pk_mul_f32 v[156:157], v[156:157], v[216:217]
    v_pk_mul_f32 v[158:159], v[158:159], v[218:219]
    ds_write_b64 v244, v[102:103] offset:928
    v_cvt_pk_bf16_f32 v144, v144, v148
    v_cvt_pk_bf16_f32 v148, v145, v149
    ds_read_b64_tr_b16 v[96:97], v245 offset:0
    ds_read_b64_tr_b16 v[98:99], v245 offset:32
    v_cvt_pk_bf16_f32 v145, v152, v156
    v_cvt_pk_bf16_f32 v149, v153, v157
    ds_read_b64_tr_b16 v[100:101], v245 offset:2560
    ds_read_b64_tr_b16 v[102:103], v245 offset:2592
    v_cvt_pk_bf16_f32 v146, v146, v150
    v_cvt_pk_bf16_f32 v150, v147, v151
    ds_write_b64 v244, v[144:145] offset:128
    v_cvt_pk_bf16_f32 v147, v154, v158
    v_cvt_pk_bf16_f32 v151, v155, v159
    ds_write_b64 v244, v[148:149] offset:416
    v_pk_mul_f32 v[136:137], v[136:137], v[216:217]
    v_pk_mul_f32 v[138:139], v[138:139], v[218:219]
    ds_write_b64 v244, v[146:147] offset:768
    v_pk_mul_f32 v[140:141], v[140:141], v[216:217]
    v_pk_mul_f32 v[142:143], v[142:143], v[218:219]
    ds_write_b64 v244, v[150:151] offset:1056
    v_pk_mul_f32 v[128:129], v[128:129], v[216:217]
    v_pk_mul_f32 v[130:131], v[130:131], v[218:219]
    ds_read_b64_tr_b16 v[144:145], v245 offset:128
    ds_read_b64_tr_b16 v[146:147], v245 offset:160
    v_pk_mul_f32 v[132:133], v[132:133], v[216:217]
    v_pk_mul_f32 v[134:135], v[134:135], v[218:219]
    ds_read_b64_tr_b16 v[148:149], v245 offset:2688
    ds_read_b64_tr_b16 v[150:151], v245 offset:2720
    s_add_u32 s34, s28, 12288
    s_waitcnt lgkmcnt(6)
    buffer_store_dwordx4 v[96:99], v247, s[16:19], s34 offen sc1 nt
    buffer_store_dwordx4 v[100:103], v247, s[16:19], s34 offen offset:2048 sc1 nt
    v_smfmac_f32_16x16x64_bf16 a[224:227], a[248:251], v[96:103], v202
    v_cvt_pk_bf16_f32 v128, v128, v132
    v_cvt_pk_bf16_f32 v132, v129, v133
    v_cvt_pk_bf16_f32 v129, v136, v140
    v_cvt_pk_bf16_f32 v133, v137, v141
    v_cvt_pk_bf16_f32 v130, v130, v134
    v_cvt_pk_bf16_f32 v134, v131, v135
    ds_write_b64 v244, v[128:129] offset:0
    v_cvt_pk_bf16_f32 v131, v138, v142
    v_cvt_pk_bf16_f32 v135, v139, v143
    ds_write_b64 v244, v[132:133] offset:288
    ds_write_b64 v244, v[130:131] offset:640
    s_add_u32 s31, s29, 16384
    s_waitcnt lgkmcnt(3)
    buffer_store_dwordx4 v[144:147], v247, s[16:19], s31 offen sc1 nt
    ds_write_b64 v244, v[134:135] offset:928
    buffer_store_dwordx4 v[148:151], v247, s[16:19], s31 offen offset:2048 sc1 nt
    v_smfmac_f32_16x16x64_bf16 a[224:227], a[248:251], v[144:151], v202
    ds_read_b64_tr_b16 v[128:129], v245 offset:0
    ds_read_b64_tr_b16 v[130:131], v245 offset:32
    ds_read_b64_tr_b16 v[132:133], v245 offset:2560
    ds_read_b64_tr_b16 v[134:135], v245 offset:2592
    s_add_u32 s30, s28, 16384
    s_waitcnt lgkmcnt(3)
    s_waitcnt lgkmcnt(2)
    buffer_store_dwordx4 v[128:131], v247, s[16:19], s30 offen sc1 nt
    s_waitcnt lgkmcnt(0)
    buffer_store_dwordx4 v[132:135], v247, s[16:19], s30 offen offset:2048 sc1 nt
    v_smfmac_f32_16x16x64_bf16 a[224:227], a[248:251], v[128:135], v202
    v_cmp_gt_f32 s[38:39], s24, v199
    v_cmp_lt_f32 s[32:33], s25, v200
    s_or_b64 s[38:39], s[38:39], s[32:33]
    s_nop 4
    v_accvgpr_read_b32 v204, a224
    v_accvgpr_read_b32 v205, a225
    v_accvgpr_read_b32 v206, a226
    v_accvgpr_read_b32 v207, a227
    v_add_f32 v204, v204, v205
    v_add_f32 v206, v206, v207
    v_add_f32 v204, v204, v206
    v_cmp_u_f32 vcc, v204, v204
    s_nop 1
    s_or_b64 s[38:39], vcc, s[38:39]
    s_cbranch_scc1 L_slow
    s_endpgm
L_slow:
    s_waitcnt vmcnt(0) lgkmcnt(0)
    v_and_b32 v197, 15, v228
    v_lshrrev_b32 v198, 4, v228
    v_lshlrev_b32 v194, 8, v197
    v_lshlrev_b32 v199, 4, v198
    v_add_u32 v194, v194, v199
    v_lshlrev_b32 v195, 10, v198
    v_lshlrev_b32 v199, 1, v197
    v_add_u32 v195, v195, v199
    v_lshlrev_b32 v196, 8, v197
    v_lshlrev_b32 v199, 3, v198
    v_add_u32 v196, v196, v199
    s_mov_b32 s24, 0
    s_mov_b32 s36, 0x3e0293ee
L_slow_tile:
    s_mul_i32 s25, s20, 20480
    s_lshl_b32 s26, s24, 12
    s_add_u32 s25, s25, s26
    s_cmp_lt_u32 s24, 5
    s_cselect_b32 s25, s25, 81920
    s_nop 4
    buffer_load_dwordx4 v[32:35], v194, s[4:7], s25 offen offset:0
    buffer_load_dwordx4 v[36:39], v194, s[4:7], s25 offen offset:64
    buffer_load_dwordx4 v[40:43], v194, s[4:7], s25 offen offset:128
    buffer_load_dwordx4 v[44:47], v194, s[4:7], s25 offen offset:192
    v_mov_b32 v192, 0xff800000
    s_mov_b32 s26, 0
L_slow_p1:
    s_add_u32 s27, s26, 4096
    s_nop 4
    buffer_load_dwordx4 v[48:51], v194, s[8:11], s26 offen offset:0
    buffer_load_dwordx4 v[52:55], v194, s[8:11], s26 offen offset:64
    buffer_load_dwordx4 v[56:59], v194, s[8:11], s26 offen offset:128
    buffer_load_dwordx4 v[60:63], v194, s[8:11], s26 offen offset:192
    buffer_load_dwordx4 v[64:67], v194, s[8:11], s27 offen offset:0
    buffer_load_dwordx4 v[68:71], v194, s[8:11], s27 offen offset:64
    buffer_load_dwordx4 v[72:75], v194, s[8:11], s27 offen offset:128
    buffer_load_dwordx4 v[76:79], v194, s[8:11], s27 offen offset:192
    s_waitcnt vmcnt(0)
    v_mfma_f32_16x16x32_bf16 v[80:83], v[48:51], v[32:35], 0
    v_mfma_f32_16x16x32_bf16 v[80:83], v[52:55], v[36:39], v[80:83]
    v_mfma_f32_16x16x32_bf16 v[80:83], v[56:59], v[40:43], v[80:83]
    v_mfma_f32_16x16x32_bf16 v[80:83], v[60:63], v[44:47], v[80:83]
    v_mfma_f32_16x16x32_bf16 v[84:87], v[64:67], v[32:35], 0
    v_mfma_f32_16x16x32_bf16 v[84:87], v[68:71], v[36:39], v[84:87]
    v_mfma_f32_16x16x32_bf16 v[84:87], v[72:75], v[40:43], v[84:87]
    v_mfma_f32_16x16x32_bf16 v[84:87], v[76:79], v[44:47], v[84:87]
    s_nop 7
    s_nop 3
    v_max3_f32 v192, v192, v80, v81
    v_max3_f32 v192, v192, v82, v83
    v_max3_f32 v192, v192, v84, v85
    v_max3_f32 v192, v192, v86, v87
    s_add_u32 s26, s26, 8192
    s_cmp_lt_u32 s26, 524288
    s_cbranch_scc1 L_slow_p1
    v_mov_b32 v197, v192
    s_nop 2
    v_permlane32_swap_b32 v192, v197
    s_nop 2
    v_max_f32 v192, v192, v197
    v_mov_b32 v197, v192
    s_nop 2
    v_permlane16_swap_b32 v192, v197
    s_nop 2
    v_max_f32 v192, v192, v197
    v_mov_b32 v0, 0
    v_mov_b32 v1, 0
    v_mov_b32 v2, 0
    v_mov_b32 v3, 0
    v_mov_b32 v4, 0
    v_mov_b32 v5, 0
    v_mov_b32 v6, 0
    v_mov_b32 v7, 0
    v_mov_b32 v8, 0
    v_mov_b32 v9, 0
    v_mov_b32 v10, 0
    v_mov_b32 v11, 0
    v_mov_b32 v12, 0
    v_mov_b32 v13, 0
    v_mov_b32 v14, 0
    v_mov_b32 v15, 0
    v_mov_b32 v16, 0
    v_mov_b32 v17, 0
    v_mov_b32 v18, 0
    v_mov_b32 v19, 0
    v_mov_b32 v20, 0
    v_mov_b32 v21, 0
    v_mov_b32 v22, 0
    v_mov_b32 v23, 0
    v_mov_b32 v24, 0
    v_mov_b32 v25, 0
    v_mov_b32 v26, 0
    v_mov_b32 v27, 0
    v_mov_b32 v28, 0
    v_mov_b32 v29, 0
    v_mov_b32 v30, 0
    v_mov_b32 v31, 0
    v_mov_b32 v193, 0
    s_mov_b32 s26, 0
L_slow_p2:
    s_add_u32 s27, s26, 4096
    s_nop 4
    buffer_load_dwordx4 v[48:51], v194, s[8:11], s26 offen offset:0
    buffer_load_dwordx4 v[52:55], v194, s[8:11], s26 offen offset:64
    buffer_load_dwordx4 v[56:59], v194, s[8:11], s26 offen offset:128
    buffer_load_dwordx4 v[60:63], v194, s[8:11], s26 offen offset:192
    buffer_load_dwordx4 v[64:67], v194, s[8:11], s27 offen offset:0
    buffer_load_dwordx4 v[68:71], v194, s[8:11], s27 offen offset:64
    buffer_load_dwordx4 v[72:75], v194, s[8:11], s27 offen offset:128
    buffer_load_dwordx4 v[76:79], v194, s[8:11], s27 offen offset:192
    s_waitcnt vmcnt(0)
    v_mfma_f32_16x16x32_bf16 v[80:83], v[48:51], v[32:35], 0
    v_mfma_f32_16x16x32_bf16 v[80:83], v[52:55], v[36:39], v[80:83]
    v_mfma_f32_16x16x32_bf16 v[80:83], v[56:59], v[40:43], v[80:83]
    v_mfma_f32_16x16x32_bf16 v[80:83], v[60:63], v[44:47], v[80:83]
    v_mfma_f32_16x16x32_bf16 v[84:87], v[64:67], v[32:35], 0
    v_mfma_f32_16x16x32_bf16 v[84:87], v[68:71], v[36:39], v[84:87]
    v_mfma_f32_16x16x32_bf16 v[84:87], v[72:75], v[40:43], v[84:87]
    v_mfma_f32_16x16x32_bf16 v[84:87], v[76:79], v[44:47], v[84:87]
    s_nop 7
    s_nop 3
    v_sub_f32 v80, v80, v192
    v_sub_f32 v81, v81, v192
    v_sub_f32 v82, v82, v192
    v_sub_f32 v83, v83, v192
    v_sub_f32 v84, v84, v192
    v_sub_f32 v85, v85, v192
    v_sub_f32 v86, v86, v192
    v_sub_f32 v87, v87, v192
    v_mul_f32 v80, s36, v80
    v_mul_f32 v81, s36, v81
    v_mul_f32 v82, s36, v82
    v_mul_f32 v83, s36, v83
    v_mul_f32 v84, s36, v84
    v_mul_f32 v85, s36, v85
    v_mul_f32 v86, s36, v86
    v_mul_f32 v87, s36, v87
    v_exp_f32 v80, v80
    v_exp_f32 v81, v81
    v_exp_f32 v82, v82
    v_exp_f32 v83, v83
    v_exp_f32 v84, v84
    v_exp_f32 v85, v85
    v_exp_f32 v86, v86
    v_exp_f32 v87, v87
    s_nop 1
    v_add_f32 v193, v193, v80
    v_add_f32 v193, v193, v81
    v_add_f32 v193, v193, v82
    v_add_f32 v193, v193, v83
    v_add_f32 v193, v193, v84
    v_add_f32 v193, v193, v85
    v_add_f32 v193, v193, v86
    v_add_f32 v193, v193, v87
    v_cvt_pk_bf16_f32 v88, v80, v81
    v_cvt_pk_bf16_f32 v89, v82, v83
    v_cvt_pk_bf16_f32 v90, v84, v85
    v_cvt_pk_bf16_f32 v91, v86, v87
    buffer_load_ushort v96, v195, s[12:15], s26 offen offset:0
    buffer_load_ushort v97, v195, s[12:15], s26 offen offset:256
    buffer_load_ushort v98, v195, s[12:15], s26 offen offset:512
    buffer_load_ushort v99, v195, s[12:15], s26 offen offset:768
    buffer_load_ushort v100, v195, s[12:15], s27 offen offset:0
    buffer_load_ushort v101, v195, s[12:15], s27 offen offset:256
    buffer_load_ushort v102, v195, s[12:15], s27 offen offset:512
    buffer_load_ushort v103, v195, s[12:15], s27 offen offset:768
    buffer_load_ushort v104, v195, s[12:15], s26 offen offset:32
    buffer_load_ushort v105, v195, s[12:15], s26 offen offset:288
    buffer_load_ushort v106, v195, s[12:15], s26 offen offset:544
    buffer_load_ushort v107, v195, s[12:15], s26 offen offset:800
    buffer_load_ushort v108, v195, s[12:15], s27 offen offset:32
    buffer_load_ushort v109, v195, s[12:15], s27 offen offset:288
    buffer_load_ushort v110, v195, s[12:15], s27 offen offset:544
    buffer_load_ushort v111, v195, s[12:15], s27 offen offset:800
    buffer_load_ushort v112, v195, s[12:15], s26 offen offset:64
    buffer_load_ushort v113, v195, s[12:15], s26 offen offset:320
    buffer_load_ushort v114, v195, s[12:15], s26 offen offset:576
    buffer_load_ushort v115, v195, s[12:15], s26 offen offset:832
    buffer_load_ushort v116, v195, s[12:15], s27 offen offset:64
    buffer_load_ushort v117, v195, s[12:15], s27 offen offset:320
    buffer_load_ushort v118, v195, s[12:15], s27 offen offset:576
    buffer_load_ushort v119, v195, s[12:15], s27 offen offset:832
    buffer_load_ushort v120, v195, s[12:15], s26 offen offset:96
    buffer_load_ushort v121, v195, s[12:15], s26 offen offset:352
    buffer_load_ushort v122, v195, s[12:15], s26 offen offset:608
    buffer_load_ushort v123, v195, s[12:15], s26 offen offset:864
    buffer_load_ushort v124, v195, s[12:15], s27 offen offset:96
    buffer_load_ushort v125, v195, s[12:15], s27 offen offset:352
    buffer_load_ushort v126, v195, s[12:15], s27 offen offset:608
    buffer_load_ushort v127, v195, s[12:15], s27 offen offset:864
    s_waitcnt vmcnt(0)
    buffer_load_ushort v128, v195, s[12:15], s26 offen offset:128
    buffer_load_ushort v129, v195, s[12:15], s26 offen offset:384
    buffer_load_ushort v130, v195, s[12:15], s26 offen offset:640
    buffer_load_ushort v131, v195, s[12:15], s26 offen offset:896
    buffer_load_ushort v132, v195, s[12:15], s27 offen offset:128
    buffer_load_ushort v133, v195, s[12:15], s27 offen offset:384
    buffer_load_ushort v134, v195, s[12:15], s27 offen offset:640
    buffer_load_ushort v135, v195, s[12:15], s27 offen offset:896
    buffer_load_ushort v136, v195, s[12:15], s26 offen offset:160
    buffer_load_ushort v137, v195, s[12:15], s26 offen offset:416
    buffer_load_ushort v138, v195, s[12:15], s26 offen offset:672
    buffer_load_ushort v139, v195, s[12:15], s26 offen offset:928
    buffer_load_ushort v140, v195, s[12:15], s27 offen offset:160
    buffer_load_ushort v141, v195, s[12:15], s27 offen offset:416
    buffer_load_ushort v142, v195, s[12:15], s27 offen offset:672
    buffer_load_ushort v143, v195, s[12:15], s27 offen offset:928
    buffer_load_ushort v144, v195, s[12:15], s26 offen offset:192
    buffer_load_ushort v145, v195, s[12:15], s26 offen offset:448
    buffer_load_ushort v146, v195, s[12:15], s26 offen offset:704
    buffer_load_ushort v147, v195, s[12:15], s26 offen offset:960
    buffer_load_ushort v148, v195, s[12:15], s27 offen offset:192
    buffer_load_ushort v149, v195, s[12:15], s27 offen offset:448
    buffer_load_ushort v150, v195, s[12:15], s27 offen offset:704
    buffer_load_ushort v151, v195, s[12:15], s27 offen offset:960
    buffer_load_ushort v152, v195, s[12:15], s26 offen offset:224
    buffer_load_ushort v153, v195, s[12:15], s26 offen offset:480
    buffer_load_ushort v154, v195, s[12:15], s26 offen offset:736
    buffer_load_ushort v155, v195, s[12:15], s26 offen offset:992
    buffer_load_ushort v156, v195, s[12:15], s27 offen offset:224
    buffer_load_ushort v157, v195, s[12:15], s27 offen offset:480
    buffer_load_ushort v158, v195, s[12:15], s27 offen offset:736
    buffer_load_ushort v159, v195, s[12:15], s27 offen offset:992
    s_waitcnt vmcnt(0)
    v_lshl_or_b32 v160, v97, 16, v96
    v_lshl_or_b32 v161, v99, 16, v98
    v_lshl_or_b32 v162, v101, 16, v100
    v_lshl_or_b32 v163, v103, 16, v102
    v_lshl_or_b32 v164, v105, 16, v104
    v_lshl_or_b32 v165, v107, 16, v106
    v_lshl_or_b32 v166, v109, 16, v108
    v_lshl_or_b32 v167, v111, 16, v110
    v_lshl_or_b32 v168, v113, 16, v112
    v_lshl_or_b32 v169, v115, 16, v114
    v_lshl_or_b32 v170, v117, 16, v116
    v_lshl_or_b32 v171, v119, 16, v118
    v_lshl_or_b32 v172, v121, 16, v120
    v_lshl_or_b32 v173, v123, 16, v122
    v_lshl_or_b32 v174, v125, 16, v124
    v_lshl_or_b32 v175, v127, 16, v126
    v_lshl_or_b32 v176, v129, 16, v128
    v_lshl_or_b32 v177, v131, 16, v130
    v_lshl_or_b32 v178, v133, 16, v132
    v_lshl_or_b32 v179, v135, 16, v134
    v_lshl_or_b32 v180, v137, 16, v136
    v_lshl_or_b32 v181, v139, 16, v138
    v_lshl_or_b32 v182, v141, 16, v140
    v_lshl_or_b32 v183, v143, 16, v142
    v_lshl_or_b32 v184, v145, 16, v144
    v_lshl_or_b32 v185, v147, 16, v146
    v_lshl_or_b32 v186, v149, 16, v148
    v_lshl_or_b32 v187, v151, 16, v150
    v_lshl_or_b32 v188, v153, 16, v152
    v_lshl_or_b32 v189, v155, 16, v154
    v_lshl_or_b32 v190, v157, 16, v156
    v_lshl_or_b32 v191, v159, 16, v158
    s_nop 2
    v_mfma_f32_16x16x32_bf16 v[0:3], v[160:163], v[88:91], v[0:3]
    v_mfma_f32_16x16x32_bf16 v[4:7], v[164:167], v[88:91], v[4:7]
    v_mfma_f32_16x16x32_bf16 v[8:11], v[168:171], v[88:91], v[8:11]
    v_mfma_f32_16x16x32_bf16 v[12:15], v[172:175], v[88:91], v[12:15]
    v_mfma_f32_16x16x32_bf16 v[16:19], v[176:179], v[88:91], v[16:19]
    v_mfma_f32_16x16x32_bf16 v[20:23], v[180:183], v[88:91], v[20:23]
    v_mfma_f32_16x16x32_bf16 v[24:27], v[184:187], v[88:91], v[24:27]
    v_mfma_f32_16x16x32_bf16 v[28:31], v[188:191], v[88:91], v[28:31]
    s_add_u32 s26, s26, 8192
    s_cmp_lt_u32 s26, 524288
    s_cbranch_scc1 L_slow_p2
    v_mov_b32 v197, v193
    s_nop 2
    v_permlane32_swap_b32 v193, v197
    s_nop 2
    v_add_f32 v193, v193, v197
    v_mov_b32 v197, v193
    s_nop 2
    v_permlane16_swap_b32 v193, v197
    s_nop 2
    v_add_f32 v193, v193, v197
    v_rcp_f32 v193, v193
    s_nop 7
    s_nop 3
    v_mul_f32 v0, v0, v193
    v_mul_f32 v1, v1, v193
    v_mul_f32 v2, v2, v193
    v_mul_f32 v3, v3, v193
    v_mul_f32 v4, v4, v193
    v_mul_f32 v5, v5, v193
    v_mul_f32 v6, v6, v193
    v_mul_f32 v7, v7, v193
    v_mul_f32 v8, v8, v193
    v_mul_f32 v9, v9, v193
    v_mul_f32 v10, v10, v193
    v_mul_f32 v11, v11, v193
    v_mul_f32 v12, v12, v193
    v_mul_f32 v13, v13, v193
    v_mul_f32 v14, v14, v193
    v_mul_f32 v15, v15, v193
    v_mul_f32 v16, v16, v193
    v_mul_f32 v17, v17, v193
    v_mul_f32 v18, v18, v193
    v_mul_f32 v19, v19, v193
    v_mul_f32 v20, v20, v193
    v_mul_f32 v21, v21, v193
    v_mul_f32 v22, v22, v193
    v_mul_f32 v23, v23, v193
    v_mul_f32 v24, v24, v193
    v_mul_f32 v25, v25, v193
    v_mul_f32 v26, v26, v193
    v_mul_f32 v27, v27, v193
    v_mul_f32 v28, v28, v193
    v_mul_f32 v29, v29, v193
    v_mul_f32 v30, v30, v193
    v_mul_f32 v31, v31, v193
    v_cvt_pk_bf16_f32 v0, v0, v1
    v_cvt_pk_bf16_f32 v1, v2, v3
    v_cvt_pk_bf16_f32 v4, v4, v5
    v_cvt_pk_bf16_f32 v5, v6, v7
    v_cvt_pk_bf16_f32 v8, v8, v9
    v_cvt_pk_bf16_f32 v9, v10, v11
    v_cvt_pk_bf16_f32 v12, v12, v13
    v_cvt_pk_bf16_f32 v13, v14, v15
    v_cvt_pk_bf16_f32 v16, v16, v17
    v_cvt_pk_bf16_f32 v17, v18, v19
    v_cvt_pk_bf16_f32 v20, v20, v21
    v_cvt_pk_bf16_f32 v21, v22, v23
    v_cvt_pk_bf16_f32 v24, v24, v25
    v_cvt_pk_bf16_f32 v25, v26, v27
    v_cvt_pk_bf16_f32 v28, v28, v29
    v_cvt_pk_bf16_f32 v29, v30, v31
    s_cmp_lt_u32 s24, 5
    s_cbranch_scc1 L_slow_st0
    s_cmp_eq_u32 s20, 0
    s_cbranch_scc0 L_slow_sk0
L_slow_st0:
    buffer_store_dwordx2 v[0:1], v196, s[16:19], s25 offen offset:0
L_slow_sk0:
    s_cmp_lt_u32 s24, 5
    s_cbranch_scc1 L_slow_st1
    s_cmp_eq_u32 s20, 0
    s_cbranch_scc0 L_slow_sk1
L_slow_st1:
    buffer_store_dwordx2 v[4:5], v196, s[16:19], s25 offen offset:32
L_slow_sk1:
    s_cmp_lt_u32 s24, 5
    s_cbranch_scc1 L_slow_st2
    s_cmp_eq_u32 s20, 1
    s_cbranch_scc0 L_slow_sk2
L_slow_st2:
    buffer_store_dwordx2 v[8:9], v196, s[16:19], s25 offen offset:64
L_slow_sk2:
    s_cmp_lt_u32 s24, 5
    s_cbranch_scc1 L_slow_st3
    s_cmp_eq_u32 s20, 1
    s_cbranch_scc0 L_slow_sk3
L_slow_st3:
    buffer_store_dwordx2 v[12:13], v196, s[16:19], s25 offen offset:96
L_slow_sk3:
    s_cmp_lt_u32 s24, 5
    s_cbranch_scc1 L_slow_st4
    s_cmp_eq_u32 s20, 2
    s_cbranch_scc0 L_slow_sk4
L_slow_st4:
    buffer_store_dwordx2 v[16:17], v196, s[16:19], s25 offen offset:128
L_slow_sk4:
    s_cmp_lt_u32 s24, 5
    s_cbranch_scc1 L_slow_st5
    s_cmp_eq_u32 s20, 2
    s_cbranch_scc0 L_slow_sk5
L_slow_st5:
    buffer_store_dwordx2 v[20:21], v196, s[16:19], s25 offen offset:160
L_slow_sk5:
    s_cmp_lt_u32 s24, 5
    s_cbranch_scc1 L_slow_st6
    s_cmp_eq_u32 s20, 3
    s_cbranch_scc0 L_slow_sk6
L_slow_st6:
    buffer_store_dwordx2 v[24:25], v196, s[16:19], s25 offen offset:192
L_slow_sk6:
    s_cmp_lt_u32 s24, 5
    s_cbranch_scc1 L_slow_st7
    s_cmp_eq_u32 s20, 3
    s_cbranch_scc0 L_slow_sk7
L_slow_st7:
    buffer_store_dwordx2 v[28:29], v196, s[16:19], s25 offen offset:224
L_slow_sk7:
    s_waitcnt vmcnt(0)
    s_add_u32 s24, s24, 1
    s_cmp_lt_u32 s24, 6
    s_cbranch_scc1 L_slow_tile
L_end:
    s_endpgm
.section .rodata,"a"
.p2align 6
.amdhsa_kernel standalone__gqa_softmax__near_ridge_kernel
  .amdhsa_next_free_vgpr 512
  .amdhsa_next_free_sgpr 102
  .amdhsa_accum_offset 256
  .amdhsa_group_segment_fixed_size 0
  .amdhsa_kernarg_size 48
  .amdhsa_user_sgpr_count 2
  .amdhsa_user_sgpr_kernarg_segment_ptr 1
  .amdhsa_system_sgpr_workgroup_id_x 1
.end_amdhsa_kernel
```
